```python
import torch

def _softmax(x, axis=-1):
    return torch.softmax(x, dim=axis)
def _gelu(x):
    return torch.nn.functional.gelu(x, approximate="tanh")
def _silu(x):
    return torch.nn.functional.silu(x)
def _sigmoid(x):
    return torch.sigmoid(x)
def _layernorm(x, axis=-1, eps=1e-5):
    m = x.mean(dim=axis, keepdim=True)
    v = x.var(dim=axis, keepdim=True, unbiased=False)
    return (x - m) / torch.sqrt(v + eps)
def _scatter_add(tgt, idx, src, axis=0):
    return tgt.clone().index_add_(axis, idx, src)
def _segment_sum(src, seg, n):
    out = torch.zeros((n,) + src.shape[1:], dtype=src.dtype)
    return out.index_add_(0, seg, src)
def _pad(x, pw):
    flat = tuple(v for pair in reversed(pw) for v in pair)
    return torch.nn.functional.pad(x, flat)

kernel_name = 'sequential_preLN__gqa_block_cached__geglu_ffn__decode'

def setup_inputs():

    _w = (lambda a: (lambda t: t.to(torch.bfloat16) if t.is_floating_point() else t)(torch.as_tensor(a)))
    def _A_setup():
        B, Sq, D = 8, 1, 512
        Hq, Hkv, Sk, Dh = 32, 8, 8192, 128
        assert Hq % Hkv == 0, (Hq, Hkv)
        return {
            "x": _w((lambda *s: torch.randn(*s, dtype=torch.bfloat16) * 0.05)(B, Sq, D)),
            "k_cache": _w((lambda *s: torch.randn(*s, dtype=torch.bfloat16) * 3.2)(B, Hkv, Sk, Dh)),
            "v_cache": _w((lambda *s: torch.randn(*s, dtype=torch.bfloat16) * 0.4)(B, Hkv, Sk, Dh)),
            "wq": _w((lambda *s: torch.randn(*s, dtype=torch.bfloat16) * 3.2)(D, Hq * Dh) * (D ** -0.5)),
            "wo": _w((lambda *s: torch.randn(*s, dtype=torch.bfloat16) * 0.4)(Hq * Dh, D) * ((Hq * Dh) ** -0.5)),
        }
    _A_in = _A_setup()

    def _B_setup():
        B, S, D, F = 8, 1, 512, 1792
        return {
            "x": _w((lambda *s: torch.randn(*s, dtype=torch.bfloat16) * 0.05)(B, S, D)),
            "w_gate": _w((lambda *s: torch.randn(*s, dtype=torch.bfloat16) * 0.05)(D, F)),
            "w_up": _w((lambda *s: torch.randn(*s, dtype=torch.bfloat16) * 0.05)(D, F)),
            "w_down": _w((lambda *s: torch.randn(*s, dtype=torch.bfloat16) * 0.05)(F, D)),
        }
    _B_in = _B_setup()

    return {
        "A_x": _A_in["x"],
        "A_k_cache": _A_in["k_cache"],
        "A_v_cache": _A_in["v_cache"],
        "A_wq": _A_in["wq"],
        "A_wo": _A_in["wo"],
        "B_x": _B_in["x"],
        "B_w_gate": _B_in["w_gate"],
        "B_w_up": _B_in["w_up"],
        "B_w_down": _B_in["w_down"],
    }

def reference(A_x, A_k_cache, A_v_cache, A_wq, A_wo, B_x, B_w_gate, B_w_up, B_w_down):
    def _A_ref(x, k_cache, v_cache, wq, wo):
        B, Sq, D = x.shape
        Hq, Dh = 32, 128
        Hkv = k_cache.shape[1]
        rep = Hq // Hkv
        q = (lambda x, *d: x.permute(*d))((x @ wq).reshape(B, Sq, Hq, Dh), 0, 2, 1, 3)
        k = (lambda x, n, axis: torch.repeat_interleave(x, n, dim=axis))(k_cache, rep, axis=1)
        v = (lambda x, n, axis: torch.repeat_interleave(x, n, dim=axis))(v_cache, rep, axis=1)
        scores = torch.einsum("bhqd,bhkd->bhqk", q, k) * (Dh ** -0.5)
        p = _softmax(scores, axis=-1)
        o = torch.einsum("bhqk,bhkd->bhqd", p, v)
        return (lambda x, *d: x.permute(*d))(o, 0, 2, 1, 3).reshape(B, Sq, Hq * Dh) @ wo

    def _B_ref(x, w_gate, w_up, w_down):
        return (_gelu(x @ w_gate) * (x @ w_up)) @ w_down

    x = A_x
    h = x + _A_ref(_layernorm(x, axis=-1), A_k_cache, A_v_cache, A_wq, A_wo)
    h2 = h + _B_ref(_layernorm(h, axis=-1), B_w_gate, B_w_up, B_w_down)
    return h2
```

```asm
; @launch grid=(256,1,1) block=(512,1,1) lds=96256
.amdgcn_target "amdgcn-amd-amdhsa--gfx950"
.text
.globl sequential_preLN__gqa_block_cached__geglu_ffn__decode_kernel
.p2align 8
.type sequential_preLN__gqa_block_cached__geglu_ffn__decode_kernel,@function
sequential_preLN__gqa_block_cached__geglu_ffn__decode_kernel:
s_cmp_ge_u32 s2, 256
s_cbranch_scc1 L_end
v_lshrrev_b32 v1, 6, v0
v_lshlrev_b32 v3, 2, v0
v_readfirstlane_b32 s52, v1
s_cmp_lt_u32 s52, 4
s_cbranch_scc1 L_noz
s_getpc_b64 s[6:7]
L_pc:
s_lshr_b32 s8, s2, 3
s_mul_i32 s8, s8, 1280
v_lshl_add_u32 v100, v3, 1, s8
v_min_u32 v100, L_last-L_pc+2048-4, v100
v_mov_b32 v101, s7
v_add_co_u32 v100, vcc, s6, v100
v_mov_b32 v30, 0
s_nop 0
v_addc_co_u32 v101, vcc, 0, v101, vcc
global_load_dword v102, v[100:101], off offset:-2048
v_mov_b32 v30, 0
ds_write_b32 v3, v30 offset:27392
ds_write_b32 v3, v30 offset:28416
s_waitcnt lgkmcnt(0)
L_noz:
s_load_dwordx16 s[16:31], s[0:1], 0
s_load_dwordx8 s[32:39], s[0:1], 64
s_barrier
v_and_b32 v0, 63, v0
s_and_b32 s48, s2, 7
s_lshr_b32 s49, s2, 3
s_lshl_b32 s50, s49, 1
s_bfe_u32 s54, s2, 0x10001
s_or_b32 s50, s50, s54
s_and_b32 s51, s2, 1
s_bfe_u32 s54, s2, 0x10002
s_lshl_b32 s54, s54, 1
s_or_b32 s51, s51, s54
s_mov_b32 s64, s51
s_bfe_u32 s50, s49, 0x30001
s_lshl_b32 s50, s50, 3
s_or_b32 s50, s50, s48
s_lshr_b32 s51, s49, 4
s_lshl_b32 s51, s51, 1
s_and_b32 s54, s49, 1
s_or_b32 s51, s51, s54
s_mov_b32 s59, 0x3fb8aa3b
s_mov_b32 s60, 0xffff0000
v_lshlrev_b32 v1, 4, v0
s_cmp_ge_u32 s52, 4
s_cbranch_scc1 L_service
s_lshl_b32 s54, s50, 21
s_lshl_b32 s62, s51, 2
s_add_u32 s62, s62, s52
s_add_u32 s8, s62, 0
s_and_b32 s8, s8, 15
s_lshl_b32 s8, s8, 12
s_add_u32 s9, s62, 4
s_and_b32 s9, s9, 15
s_lshl_b32 s9, s9, 12
s_add_u32 s10, s62, 8
s_and_b32 s10, s10, 15
s_lshl_b32 s10, s10, 12
s_add_u32 s11, s62, 12
s_and_b32 s11, s11, 15
s_lshl_b32 s11, s11, 12
v_lshrrev_b32 v2, 4, v0
v_lshlrev_b32 v2, 6, v2
v_and_b32 v4, 3, v0
v_lshl_add_u32 v2, v4, 4, v2
v_bfe_u32 v5, v0, 2, 2
v_lshl_add_u32 v2, v5, 8, v2
s_mov_b32 s42, 0x200000
s_mov_b32 s43, 0x20000
s_mov_b32 s46, 0x200000
s_mov_b32 s47, 0x20000
s_waitcnt lgkmcnt(0)
s_add_u32 s40, s18, s54
s_addc_u32 s41, s19, 0
s_and_b32 s41, s41, 0xffff
s_add_u32 s44, s20, s54
s_addc_u32 s45, s21, 0
s_and_b32 s45, s45, 0xffff
s_add_u32 s65, s8, 0
buffer_load_dwordx4 v[32:35], v2, s[40:43], s65 offen offset:0 nt
buffer_load_dwordx4 v[36:39], v2, s[40:43], s65 offen offset:1024 nt
buffer_load_dwordx4 v[40:43], v2, s[40:43], s65 offen offset:2048 nt
buffer_load_dwordx4 v[44:47], v2, s[40:43], s65 offen offset:3072 nt
s_add_u32 s65, s9, 65536
buffer_load_dwordx4 v[48:51], v2, s[40:43], s65 offen offset:0 nt
s_mov_b32 s13, 2
s_lshr_b32 s55, s49, 2
s_cmp_eq_u32 s55, 3
s_cselect_b32 s13, 5, s13
s_bfe_u32 s55, s49, 0x30001
s_cmp_ge_u32 s49, 16
s_cselect_b32 s14, 1, 0
s_add_u32 s13, s13, s14
s_and_b32 s55, s55, 3
s_cmp_eq_u32 s55, 1
s_cselect_b32 s14, 2, 1
s_xor_b32 s55, s2, s49
s_and_b32 s55, s55, 1
s_cselect_b32 s13, s14, s13
s_mov_b32 s68, 0x000f000f
s_mov_b32 s69, 0x000f000f
s_mov_b32 s56, 0x05040100
s_mov_b32 s57, 0x07060302
s_mov_b32 s58, 0x3db504f3
s_lshl_b32 s54, s50, 9
s_add_u32 s54, s54, 3801088
s_add_u32 s66, s38, s54
s_addc_u32 s67, s39, 0
s_lshl_b32 s55, s52, 11
v_lshlrev_b32 v4, 9, v4
v_and_b32 v0, 0x30, v0
v_add3_u32 v0, v4, v0, s55
v_mov_b32 v14, 0xff800000
s_waitcnt vmcnt(4)
buffer_load_dwordx4 v[52:55], v2, s[40:43], s65 offen offset:1024 nt
s_waitcnt vmcnt(4)
buffer_load_dwordx4 v[56:59], v2, s[40:43], s65 offen offset:2048 nt
s_waitcnt vmcnt(4)
buffer_load_dwordx4 v[60:63], v2, s[40:43], s65 offen offset:3072 nt
s_add_u32 s65, s10, 131072
s_cmp_gt_u32 s13, 1
s_cselect_b64 vcc, -1, 0
s_waitcnt vmcnt(7)
s_cbranch_vccnz L_bo_1
s_waitcnt vmcnt(4)
L_bo_1:
buffer_load_dwordx4 v[64:67], v2, s[40:43], s65 offen offset:0 nt
s_waitcnt vmcnt(7)
s_cbranch_vccnz L_bo_2
s_waitcnt vmcnt(4)
L_bo_2:
buffer_load_dwordx4 v[68:71], v2, s[40:43], s65 offen offset:1024 nt
s_waitcnt vmcnt(7)
s_cbranch_vccnz L_bo_3
s_waitcnt vmcnt(4)
L_bo_3:
buffer_load_dwordx4 v[72:75], v2, s[40:43], s65 offen offset:2048 nt
s_waitcnt vmcnt(7)
s_cbranch_vccnz L_bo_4
s_waitcnt vmcnt(4)
L_bo_4:
buffer_load_dwordx4 v[76:79], v2, s[40:43], s65 offen offset:3072 nt
s_add_u32 s65, s11, 196608
s_waitcnt vmcnt(7)
s_cbranch_vccnz L_bo_5
s_waitcnt vmcnt(4)
L_bo_5:
buffer_load_dwordx4 v[80:83], v2, s[40:43], s65 offen offset:0 nt
s_waitcnt vmcnt(7)
s_cbranch_vccnz L_bo_6
s_waitcnt vmcnt(4)
L_bo_6:
buffer_load_dwordx4 v[84:87], v2, s[40:43], s65 offen offset:1024 nt
s_waitcnt vmcnt(7)
s_cbranch_vccnz L_bo_7
s_waitcnt vmcnt(4)
L_bo_7:
buffer_load_dwordx4 v[88:91], v2, s[40:43], s65 offen offset:2048 nt
s_waitcnt vmcnt(7)
s_cbranch_vccnz L_bo_8
s_waitcnt vmcnt(4)
L_bo_8:
buffer_load_dwordx4 v[92:95], v2, s[40:43], s65 offen offset:3072 nt
v_mov_b32 v30, 2
ds_write_b32 v3, v30 offset:28416
s_add_u32 s65, s8, 262144
s_cmp_gt_u32 s13, 2
s_cselect_b64 vcc, -1, 0
s_waitcnt vmcnt(7)
s_cbranch_vccnz L_bo_9
s_waitcnt vmcnt(4)
L_bo_9:
buffer_load_dwordx4 v[96:99], v2, s[40:43], s65 offen offset:0 nt
s_waitcnt vmcnt(7)
s_cbranch_vccnz L_bo_10
s_waitcnt vmcnt(4)
L_bo_10:
buffer_load_dwordx4 v[100:103], v2, s[40:43], s65 offen offset:1024 nt
s_waitcnt vmcnt(7)
s_cbranch_vccnz L_bo_11
s_waitcnt vmcnt(4)
L_bo_11:
buffer_load_dwordx4 v[104:107], v2, s[40:43], s65 offen offset:2048 nt
s_waitcnt vmcnt(7)
s_cbranch_vccnz L_bo_12
s_waitcnt vmcnt(4)
L_bo_12:
buffer_load_dwordx4 v[108:111], v2, s[40:43], s65 offen offset:3072 nt
s_add_u32 s65, s9, 327680
s_waitcnt vmcnt(7)
s_cbranch_vccnz L_bo_13
s_waitcnt vmcnt(4)
L_bo_13:
buffer_load_dwordx4 v[112:115], v2, s[40:43], s65 offen offset:0 nt
s_waitcnt vmcnt(7)
s_cbranch_vccnz L_bo_14
s_waitcnt vmcnt(4)
L_bo_14:
buffer_load_dwordx4 v[116:119], v2, s[40:43], s65 offen offset:1024 nt
s_waitcnt vmcnt(7)
s_cbranch_vccnz L_bo_15
s_waitcnt vmcnt(4)
L_bo_15:
buffer_load_dwordx4 v[120:123], v2, s[40:43], s65 offen offset:2048 nt
s_waitcnt vmcnt(7)
s_cbranch_vccnz L_bo_16
s_waitcnt vmcnt(4)
L_bo_16:
buffer_load_dwordx4 v[124:127], v2, s[40:43], s65 offen offset:3072 nt
v_mov_b32 v30, 3
ds_write_b32 v3, v30 offset:28416
s_add_u32 s65, s10, 393216
s_cmp_gt_u32 s13, 3
s_cselect_b64 vcc, -1, 0
s_waitcnt vmcnt(7)
s_cbranch_vccnz L_bo_17
s_waitcnt vmcnt(4)
L_bo_17:
buffer_load_dwordx4 v[128:131], v2, s[40:43], s65 offen offset:0 nt
s_waitcnt vmcnt(7)
s_cbranch_vccnz L_bo_18
s_waitcnt vmcnt(4)
L_bo_18:
buffer_load_dwordx4 v[132:135], v2, s[40:43], s65 offen offset:1024 nt
s_waitcnt vmcnt(7)
s_cbranch_vccnz L_bo_19
s_waitcnt vmcnt(4)
L_bo_19:
buffer_load_dwordx4 v[136:139], v2, s[40:43], s65 offen offset:2048 nt
s_waitcnt vmcnt(7)
s_cbranch_vccnz L_bo_20
s_waitcnt vmcnt(4)
L_bo_20:
buffer_load_dwordx4 v[140:143], v2, s[40:43], s65 offen offset:3072 nt
s_add_u32 s65, s11, 458752
s_waitcnt vmcnt(7)
s_cbranch_vccnz L_bo_21
s_waitcnt vmcnt(4)
L_bo_21:
buffer_load_dwordx4 v[144:147], v2, s[40:43], s65 offen offset:0 nt
s_waitcnt vmcnt(7)
s_cbranch_vccnz L_bo_22
s_waitcnt vmcnt(4)
L_bo_22:
buffer_load_dwordx4 v[148:151], v2, s[40:43], s65 offen offset:1024 nt
s_waitcnt vmcnt(7)
s_cbranch_vccnz L_bo_23
s_waitcnt vmcnt(4)
L_bo_23:
buffer_load_dwordx4 v[152:155], v2, s[40:43], s65 offen offset:2048 nt
s_waitcnt vmcnt(7)
s_cbranch_vccnz L_bo_24
s_waitcnt vmcnt(4)
L_bo_24:
buffer_load_dwordx4 v[156:159], v2, s[40:43], s65 offen offset:3072 nt
v_mov_b32 v30, 4
ds_write_b32 v3, v30 offset:28416
s_add_u32 s65, s8, 524288
s_cmp_gt_u32 s13, 4
s_cselect_b64 vcc, -1, 0
s_waitcnt vmcnt(7)
s_cbranch_vccnz L_bo_25
s_waitcnt vmcnt(4)
L_bo_25:
buffer_load_dwordx4 v[160:163], v2, s[40:43], s65 offen offset:0 nt
s_waitcnt vmcnt(7)
s_cbranch_vccnz L_bo_26
s_waitcnt vmcnt(4)
L_bo_26:
buffer_load_dwordx4 v[164:167], v2, s[40:43], s65 offen offset:1024 nt
s_waitcnt vmcnt(7)
s_cbranch_vccnz L_bo_27
s_waitcnt vmcnt(4)
L_bo_27:
buffer_load_dwordx4 v[168:171], v2, s[40:43], s65 offen offset:2048 nt
s_waitcnt vmcnt(7)
s_cbranch_vccnz L_bo_28
s_waitcnt vmcnt(4)
L_bo_28:
buffer_load_dwordx4 v[172:175], v2, s[40:43], s65 offen offset:3072 nt
s_add_u32 s65, s9, 589824
s_waitcnt vmcnt(7)
s_cbranch_vccnz L_bo_29
s_waitcnt vmcnt(4)
L_bo_29:
buffer_load_dwordx4 v[176:179], v2, s[40:43], s65 offen offset:0 nt
s_waitcnt vmcnt(7)
s_cbranch_vccnz L_bo_30
s_waitcnt vmcnt(4)
L_bo_30:
buffer_load_dwordx4 v[180:183], v2, s[40:43], s65 offen offset:1024 nt
s_waitcnt vmcnt(7)
s_cbranch_vccnz L_bo_31
s_waitcnt vmcnt(4)
L_bo_31:
buffer_load_dwordx4 v[184:187], v2, s[40:43], s65 offen offset:2048 nt
s_waitcnt vmcnt(7)
s_cbranch_vccnz L_bo_32
s_waitcnt vmcnt(4)
L_bo_32:
buffer_load_dwordx4 v[188:191], v2, s[40:43], s65 offen offset:3072 nt
v_mov_b32 v30, 5
ds_write_b32 v3, v30 offset:28416
s_add_u32 s65, s10, 655360
s_cmp_gt_u32 s13, 5
s_cselect_b64 vcc, -1, 0
s_waitcnt vmcnt(7)
s_cbranch_vccnz L_bo_33
s_waitcnt vmcnt(4)
L_bo_33:
buffer_load_dwordx4 v[192:195], v2, s[40:43], s65 offen offset:0 nt
s_waitcnt vmcnt(7)
s_cbranch_vccnz L_bo_34
s_waitcnt vmcnt(4)
L_bo_34:
buffer_load_dwordx4 v[196:199], v2, s[40:43], s65 offen offset:1024 nt
s_waitcnt vmcnt(7)
s_cbranch_vccnz L_bo_35
s_waitcnt vmcnt(4)
L_bo_35:
buffer_load_dwordx4 v[200:203], v2, s[40:43], s65 offen offset:2048 nt
s_waitcnt vmcnt(7)
s_cbranch_vccnz L_bo_36
s_waitcnt vmcnt(4)
L_bo_36:
buffer_load_dwordx4 v[204:207], v2, s[40:43], s65 offen offset:3072 nt
s_add_u32 s65, s11, 720896
s_waitcnt vmcnt(7)
s_cbranch_vccnz L_bo_37
s_waitcnt vmcnt(4)
L_bo_37:
buffer_load_dwordx4 v[208:211], v2, s[40:43], s65 offen offset:0 nt
s_waitcnt vmcnt(7)
s_cbranch_vccnz L_bo_38
s_waitcnt vmcnt(4)
L_bo_38:
buffer_load_dwordx4 v[212:215], v2, s[40:43], s65 offen offset:1024 nt
s_waitcnt vmcnt(7)
s_cbranch_vccnz L_bo_39
s_waitcnt vmcnt(4)
L_bo_39:
buffer_load_dwordx4 v[216:219], v2, s[40:43], s65 offen offset:2048 nt
s_waitcnt vmcnt(7)
s_cbranch_vccnz L_bo_40
s_waitcnt vmcnt(4)
L_bo_40:
buffer_load_dwordx4 v[220:223], v2, s[40:43], s65 offen offset:3072 nt
v_mov_b32 v30, 6
ds_write_b32 v3, v30 offset:28416
s_add_u32 s65, s8, 786432
s_cmp_gt_u32 s13, 6
s_cselect_b64 vcc, -1, 0
s_waitcnt vmcnt(4)
buffer_load_dwordx4 v[224:227], v2, s[40:43], s65 offen offset:0 nt
s_waitcnt vmcnt(4)
buffer_load_dwordx4 v[228:231], v2, s[40:43], s65 offen offset:1024 nt
s_waitcnt vmcnt(4)
buffer_load_dwordx4 v[232:235], v2, s[40:43], s65 offen offset:2048 nt
s_waitcnt vmcnt(4)
buffer_load_dwordx4 v[236:239], v2, s[40:43], s65 offen offset:3072 nt
s_add_u32 s65, s9, 851968
s_waitcnt vmcnt(4)
buffer_load_dwordx4 v[240:243], v2, s[40:43], s65 offen offset:0 nt
s_waitcnt vmcnt(4)
buffer_load_dwordx4 v[244:247], v2, s[40:43], s65 offen offset:1024 nt
s_waitcnt vmcnt(4)
buffer_load_dwordx4 v[248:251], v2, s[40:43], s65 offen offset:2048 nt
s_waitcnt vmcnt(4)
buffer_load_dwordx4 v[252:255], v2, s[40:43], s65 offen offset:3072 nt
v_mov_b32 v30, 7
ds_write_b32 v3, v30 offset:28416
v_mov_b32 v31, 0
s_mov_b32 s61, 8388608
L_qw:
ds_read_b32 v15, v31 offset:29456
s_waitcnt lgkmcnt(0)
v_readfirstlane_b32 s54, v15
s_cmp_lg_u32 s54, 0
s_cbranch_scc1 L_qwd
s_sub_u32 s61, s61, 1
s_cmp_lg_u32 s61, 0
s_cbranch_scc1 L_qw
L_qwd:
ds_read_b128 v[4:7], v1 offset:256
s_waitcnt lgkmcnt(0)
v_mfma_f32_16x16x32_bf16 v[20:23], v[32:35], v[4:7], 0
v_mfma_f32_16x16x32_bf16 v[32:35], v[36:39], v[4:7], 0
v_mfma_f32_16x16x32_bf16 v[36:39], v[40:43], v[4:7], 0
v_mfma_f32_16x16x32_bf16 v[40:43], v[44:47], v[4:7], 0
v_mfma_f32_16x16x32_bf16 v[44:47], v[48:51], v[4:7], 0
v_mfma_f32_16x16x32_bf16 v[48:51], v[52:55], v[4:7], 0
v_mfma_f32_16x16x32_bf16 v[52:55], v[56:59], v[4:7], 0
v_mfma_f32_16x16x32_bf16 v[56:59], v[60:63], v[4:7], 0
s_nop 1
v_add_f32_dpp v18, v21, v20 row_ror:12 row_mask:0xf bank_mask:0x1
v_add_f32_dpp v19, v33, v32 row_ror:12 row_mask:0xf bank_mask:0x1
s_nop 0
v_add_f32_dpp v18, v22, v18 row_ror:8 row_mask:0xf bank_mask:0x1
v_add_f32_dpp v19, v34, v19 row_ror:8 row_mask:0xf bank_mask:0x1
s_nop 0
v_add_f32_dpp v18, v23, v18 row_ror:4 row_mask:0xf bank_mask:0x1
v_add_f32_dpp v19, v35, v19 row_ror:4 row_mask:0xf bank_mask:0x1
s_nop 0
v_add_f32_dpp v18, v38, v37 row_ror:12 row_mask:0xf bank_mask:0x2
v_add_f32_dpp v19, v42, v41 row_ror:12 row_mask:0xf bank_mask:0x2
s_nop 0
v_add_f32_dpp v18, v39, v18 row_ror:8 row_mask:0xf bank_mask:0x2
v_add_f32_dpp v19, v43, v19 row_ror:8 row_mask:0xf bank_mask:0x2
s_nop 0
v_add_f32_dpp v18, v36, v18 row_ror:4 row_mask:0xf bank_mask:0x2
v_add_f32_dpp v19, v40, v19 row_ror:4 row_mask:0xf bank_mask:0x2
s_nop 0
v_add_f32_dpp v18, v47, v46 row_ror:12 row_mask:0xf bank_mask:0x4
v_add_f32_dpp v19, v51, v50 row_ror:12 row_mask:0xf bank_mask:0x4
s_nop 0
v_add_f32_dpp v18, v44, v18 row_ror:8 row_mask:0xf bank_mask:0x4
v_add_f32_dpp v19, v48, v19 row_ror:8 row_mask:0xf bank_mask:0x4
s_nop 0
v_add_f32_dpp v18, v45, v18 row_ror:4 row_mask:0xf bank_mask:0x4
v_add_f32_dpp v19, v49, v19 row_ror:4 row_mask:0xf bank_mask:0x4
s_nop 0
v_add_f32_dpp v18, v52, v55 row_ror:12 row_mask:0xf bank_mask:0x8
v_add_f32_dpp v19, v56, v59 row_ror:12 row_mask:0xf bank_mask:0x8
s_nop 0
v_add_f32_dpp v18, v53, v18 row_ror:8 row_mask:0xf bank_mask:0x8
v_add_f32_dpp v19, v57, v19 row_ror:8 row_mask:0xf bank_mask:0x8
s_nop 0
v_add_f32_dpp v18, v54, v18 row_ror:4 row_mask:0xf bank_mask:0x8
v_add_f32_dpp v19, v58, v19 row_ror:4 row_mask:0xf bank_mask:0x8
s_nop 0
v_cvt_pk_bf16_f32 v15, 0, v18
v_cvt_pk_bf16_f32 v16, 0, v19
v_mul_f32 v15, s58, v15
v_mul_f32 v16, s58, v16
v_cvt_pk_bf16_f32 v8, v15, v16
v_cvt_pk_bf16_f32 v15, 0, v15
v_cvt_pk_bf16_f32 v16, 0, v16
v_max3_f32 v14, v14, v15, v16
v_mfma_f32_16x16x32_bf16 v[32:35], v[64:67], v[4:7], 0
v_mfma_f32_16x16x32_bf16 v[36:39], v[68:71], v[4:7], 0
v_mfma_f32_16x16x32_bf16 v[40:43], v[72:75], v[4:7], 0
v_mfma_f32_16x16x32_bf16 v[44:47], v[76:79], v[4:7], 0
v_mfma_f32_16x16x32_bf16 v[48:51], v[80:83], v[4:7], 0
v_mfma_f32_16x16x32_bf16 v[52:55], v[84:87], v[4:7], 0
v_mfma_f32_16x16x32_bf16 v[56:59], v[88:91], v[4:7], 0
v_mfma_f32_16x16x32_bf16 v[60:63], v[92:95], v[4:7], 0
s_nop 1
v_add_f32_dpp v18, v33, v32 row_ror:12 row_mask:0xf bank_mask:0x1
v_add_f32_dpp v19, v37, v36 row_ror:12 row_mask:0xf bank_mask:0x1
s_nop 0
v_add_f32_dpp v18, v34, v18 row_ror:8 row_mask:0xf bank_mask:0x1
v_add_f32_dpp v19, v38, v19 row_ror:8 row_mask:0xf bank_mask:0x1
s_nop 0
v_add_f32_dpp v18, v35, v18 row_ror:4 row_mask:0xf bank_mask:0x1
v_add_f32_dpp v19, v39, v19 row_ror:4 row_mask:0xf bank_mask:0x1
s_nop 0
s_add_u32 s65, s10, 917504
s_cmp_gt_u32 s13, 7
s_cselect_b64 vcc, -1, 0
s_waitcnt vmcnt(4)
buffer_load_dwordx4 v[64:67], v2, s[40:43], s65 offen offset:0 nt
v_add_f32_dpp v18, v42, v41 row_ror:12 row_mask:0xf bank_mask:0x2
v_add_f32_dpp v19, v46, v45 row_ror:12 row_mask:0xf bank_mask:0x2
s_nop 0
v_add_f32_dpp v18, v43, v18 row_ror:8 row_mask:0xf bank_mask:0x2
v_add_f32_dpp v19, v47, v19 row_ror:8 row_mask:0xf bank_mask:0x2
s_nop 0
v_add_f32_dpp v18, v40, v18 row_ror:4 row_mask:0xf bank_mask:0x2
v_add_f32_dpp v19, v44, v19 row_ror:4 row_mask:0xf bank_mask:0x2
s_nop 0
s_waitcnt vmcnt(4)
buffer_load_dwordx4 v[68:71], v2, s[40:43], s65 offen offset:1024 nt
v_add_f32_dpp v18, v51, v50 row_ror:12 row_mask:0xf bank_mask:0x4
v_add_f32_dpp v19, v55, v54 row_ror:12 row_mask:0xf bank_mask:0x4
s_nop 0
v_add_f32_dpp v18, v48, v18 row_ror:8 row_mask:0xf bank_mask:0x4
v_add_f32_dpp v19, v52, v19 row_ror:8 row_mask:0xf bank_mask:0x4
s_nop 0
v_add_f32_dpp v18, v49, v18 row_ror:4 row_mask:0xf bank_mask:0x4
v_add_f32_dpp v19, v53, v19 row_ror:4 row_mask:0xf bank_mask:0x4
s_nop 0
s_waitcnt vmcnt(4)
buffer_load_dwordx4 v[72:75], v2, s[40:43], s65 offen offset:2048 nt
v_add_f32_dpp v18, v56, v59 row_ror:12 row_mask:0xf bank_mask:0x8
v_add_f32_dpp v19, v60, v63 row_ror:12 row_mask:0xf bank_mask:0x8
s_nop 0
v_add_f32_dpp v18, v57, v18 row_ror:8 row_mask:0xf bank_mask:0x8
v_add_f32_dpp v19, v61, v19 row_ror:8 row_mask:0xf bank_mask:0x8
s_nop 0
v_add_f32_dpp v18, v58, v18 row_ror:4 row_mask:0xf bank_mask:0x8
v_add_f32_dpp v19, v62, v19 row_ror:4 row_mask:0xf bank_mask:0x8
s_nop 0
v_cvt_pk_bf16_f32 v15, 0, v18
v_cvt_pk_bf16_f32 v16, 0, v19
v_mul_f32 v15, s58, v15
v_mul_f32 v16, s58, v16
v_cvt_pk_bf16_f32 v9, v15, v16
v_cvt_pk_bf16_f32 v15, 0, v15
v_cvt_pk_bf16_f32 v16, 0, v16
v_max3_f32 v14, v14, v15, v16
s_waitcnt vmcnt(4)
buffer_load_dwordx4 v[76:79], v2, s[40:43], s65 offen offset:3072 nt
v_mfma_f32_16x16x32_bf16 v[32:35], v[96:99], v[4:7], 0
v_mfma_f32_16x16x32_bf16 v[36:39], v[100:103], v[4:7], 0
v_mfma_f32_16x16x32_bf16 v[40:43], v[104:107], v[4:7], 0
v_mfma_f32_16x16x32_bf16 v[44:47], v[108:111], v[4:7], 0
v_mfma_f32_16x16x32_bf16 v[48:51], v[112:115], v[4:7], 0
v_mfma_f32_16x16x32_bf16 v[52:55], v[116:119], v[4:7], 0
v_mfma_f32_16x16x32_bf16 v[56:59], v[120:123], v[4:7], 0
v_mfma_f32_16x16x32_bf16 v[60:63], v[124:127], v[4:7], 0
s_nop 1
v_add_f32_dpp v18, v33, v32 row_ror:12 row_mask:0xf bank_mask:0x1
v_add_f32_dpp v19, v37, v36 row_ror:12 row_mask:0xf bank_mask:0x1
s_nop 0
v_add_f32_dpp v18, v34, v18 row_ror:8 row_mask:0xf bank_mask:0x1
v_add_f32_dpp v19, v38, v19 row_ror:8 row_mask:0xf bank_mask:0x1
s_nop 0
v_add_f32_dpp v18, v35, v18 row_ror:4 row_mask:0xf bank_mask:0x1
v_add_f32_dpp v19, v39, v19 row_ror:4 row_mask:0xf bank_mask:0x1
s_nop 0
s_add_u32 s65, s11, 983040
s_waitcnt vmcnt(4)
buffer_load_dwordx4 v[80:83], v2, s[40:43], s65 offen offset:0 nt
v_add_f32_dpp v18, v42, v41 row_ror:12 row_mask:0xf bank_mask:0x2
v_add_f32_dpp v19, v46, v45 row_ror:12 row_mask:0xf bank_mask:0x2
s_nop 0
v_add_f32_dpp v18, v43, v18 row_ror:8 row_mask:0xf bank_mask:0x2
v_add_f32_dpp v19, v47, v19 row_ror:8 row_mask:0xf bank_mask:0x2
s_nop 0
v_add_f32_dpp v18, v40, v18 row_ror:4 row_mask:0xf bank_mask:0x2
v_add_f32_dpp v19, v44, v19 row_ror:4 row_mask:0xf bank_mask:0x2
s_nop 0
s_waitcnt vmcnt(4)
buffer_load_dwordx4 v[84:87], v2, s[40:43], s65 offen offset:1024 nt
v_add_f32_dpp v18, v51, v50 row_ror:12 row_mask:0xf bank_mask:0x4
v_add_f32_dpp v19, v55, v54 row_ror:12 row_mask:0xf bank_mask:0x4
s_nop 0
v_add_f32_dpp v18, v48, v18 row_ror:8 row_mask:0xf bank_mask:0x4
v_add_f32_dpp v19, v52, v19 row_ror:8 row_mask:0xf bank_mask:0x4
s_nop 0
v_add_f32_dpp v18, v49, v18 row_ror:4 row_mask:0xf bank_mask:0x4
v_add_f32_dpp v19, v53, v19 row_ror:4 row_mask:0xf bank_mask:0x4
s_nop 0
s_waitcnt vmcnt(4)
buffer_load_dwordx4 v[88:91], v2, s[40:43], s65 offen offset:2048 nt
v_add_f32_dpp v18, v56, v59 row_ror:12 row_mask:0xf bank_mask:0x8
v_add_f32_dpp v19, v60, v63 row_ror:12 row_mask:0xf bank_mask:0x8
s_nop 0
v_add_f32_dpp v18, v57, v18 row_ror:8 row_mask:0xf bank_mask:0x8
v_add_f32_dpp v19, v61, v19 row_ror:8 row_mask:0xf bank_mask:0x8
s_nop 0
v_add_f32_dpp v18, v58, v18 row_ror:4 row_mask:0xf bank_mask:0x8
v_add_f32_dpp v19, v62, v19 row_ror:4 row_mask:0xf bank_mask:0x8
s_nop 0
v_cvt_pk_bf16_f32 v15, 0, v18
v_cvt_pk_bf16_f32 v16, 0, v19
v_mul_f32 v15, s58, v15
v_mul_f32 v16, s58, v16
v_cvt_pk_bf16_f32 v10, v15, v16
v_cvt_pk_bf16_f32 v15, 0, v15
v_cvt_pk_bf16_f32 v16, 0, v16
v_max3_f32 v14, v14, v15, v16
s_waitcnt vmcnt(4)
buffer_load_dwordx4 v[92:95], v2, s[40:43], s65 offen offset:3072 nt
v_mov_b32 v30, 8
ds_write_b32 v3, v30 offset:28416
v_mfma_f32_16x16x32_bf16 v[32:35], v[128:131], v[4:7], 0
v_mfma_f32_16x16x32_bf16 v[36:39], v[132:135], v[4:7], 0
v_mfma_f32_16x16x32_bf16 v[40:43], v[136:139], v[4:7], 0
v_mfma_f32_16x16x32_bf16 v[44:47], v[140:143], v[4:7], 0
v_mfma_f32_16x16x32_bf16 v[48:51], v[144:147], v[4:7], 0
v_mfma_f32_16x16x32_bf16 v[52:55], v[148:151], v[4:7], 0
v_mfma_f32_16x16x32_bf16 v[56:59], v[152:155], v[4:7], 0
v_mfma_f32_16x16x32_bf16 v[60:63], v[156:159], v[4:7], 0
s_nop 1
v_add_f32_dpp v18, v33, v32 row_ror:12 row_mask:0xf bank_mask:0x1
v_add_f32_dpp v19, v37, v36 row_ror:12 row_mask:0xf bank_mask:0x1
s_nop 0
v_add_f32_dpp v18, v34, v18 row_ror:8 row_mask:0xf bank_mask:0x1
v_add_f32_dpp v19, v38, v19 row_ror:8 row_mask:0xf bank_mask:0x1
s_nop 0
v_add_f32_dpp v18, v35, v18 row_ror:4 row_mask:0xf bank_mask:0x1
v_add_f32_dpp v19, v39, v19 row_ror:4 row_mask:0xf bank_mask:0x1
s_nop 0
s_add_u32 s65, s8, 1048576
s_cmp_gt_u32 s13, 8
s_cselect_b64 vcc, -1, 0
s_waitcnt vmcnt(4)
buffer_load_dwordx4 v[96:99], v2, s[40:43], s65 offen offset:0 nt
v_add_f32_dpp v18, v42, v41 row_ror:12 row_mask:0xf bank_mask:0x2
v_add_f32_dpp v19, v46, v45 row_ror:12 row_mask:0xf bank_mask:0x2
s_nop 0
v_add_f32_dpp v18, v43, v18 row_ror:8 row_mask:0xf bank_mask:0x2
v_add_f32_dpp v19, v47, v19 row_ror:8 row_mask:0xf bank_mask:0x2
s_nop 0
v_add_f32_dpp v18, v40, v18 row_ror:4 row_mask:0xf bank_mask:0x2
v_add_f32_dpp v19, v44, v19 row_ror:4 row_mask:0xf bank_mask:0x2
s_nop 0
v_add_f32_dpp v18, v51, v50 row_ror:12 row_mask:0xf bank_mask:0x4
v_add_f32_dpp v19, v55, v54 row_ror:12 row_mask:0xf bank_mask:0x4
s_nop 0
v_add_f32_dpp v18, v48, v18 row_ror:8 row_mask:0xf bank_mask:0x4
v_add_f32_dpp v19, v52, v19 row_ror:8 row_mask:0xf bank_mask:0x4
s_nop 0
v_add_f32_dpp v18, v49, v18 row_ror:4 row_mask:0xf bank_mask:0x4
v_add_f32_dpp v19, v53, v19 row_ror:4 row_mask:0xf bank_mask:0x4
s_nop 0
s_waitcnt vmcnt(4)
buffer_load_dwordx4 v[100:103], v2, s[40:43], s65 offen offset:1024 nt
v_add_f32_dpp v18, v56, v59 row_ror:12 row_mask:0xf bank_mask:0x8
v_add_f32_dpp v19, v60, v63 row_ror:12 row_mask:0xf bank_mask:0x8
s_nop 0
v_add_f32_dpp v18, v57, v18 row_ror:8 row_mask:0xf bank_mask:0x8
v_add_f32_dpp v19, v61, v19 row_ror:8 row_mask:0xf bank_mask:0x8
s_nop 0
v_add_f32_dpp v18, v58, v18 row_ror:4 row_mask:0xf bank_mask:0x8
v_add_f32_dpp v19, v62, v19 row_ror:4 row_mask:0xf bank_mask:0x8
s_nop 0
v_cvt_pk_bf16_f32 v15, 0, v18
v_cvt_pk_bf16_f32 v16, 0, v19
v_mul_f32 v15, s58, v15
v_mul_f32 v16, s58, v16
v_cvt_pk_bf16_f32 v11, v15, v16
v_cvt_pk_bf16_f32 v15, 0, v15
v_cvt_pk_bf16_f32 v16, 0, v16
v_max3_f32 v14, v14, v15, v16
s_waitcnt vmcnt(4)
buffer_load_dwordx4 v[104:107], v2, s[40:43], s65 offen offset:2048 nt
v_mfma_f32_16x16x32_bf16 v[32:35], v[160:163], v[4:7], 0
v_mfma_f32_16x16x32_bf16 v[36:39], v[164:167], v[4:7], 0
v_mfma_f32_16x16x32_bf16 v[40:43], v[168:171], v[4:7], 0
v_mfma_f32_16x16x32_bf16 v[44:47], v[172:175], v[4:7], 0
v_mfma_f32_16x16x32_bf16 v[48:51], v[176:179], v[4:7], 0
v_mfma_f32_16x16x32_bf16 v[52:55], v[180:183], v[4:7], 0
v_mfma_f32_16x16x32_bf16 v[56:59], v[184:187], v[4:7], 0
v_mfma_f32_16x16x32_bf16 v[60:63], v[188:191], v[4:7], 0
s_nop 1
v_add_f32_dpp v18, v33, v32 row_ror:12 row_mask:0xf bank_mask:0x1
v_add_f32_dpp v19, v37, v36 row_ror:12 row_mask:0xf bank_mask:0x1
s_nop 0
v_add_f32_dpp v18, v34, v18 row_ror:8 row_mask:0xf bank_mask:0x1
v_add_f32_dpp v19, v38, v19 row_ror:8 row_mask:0xf bank_mask:0x1
s_nop 0
v_add_f32_dpp v18, v35, v18 row_ror:4 row_mask:0xf bank_mask:0x1
v_add_f32_dpp v19, v39, v19 row_ror:4 row_mask:0xf bank_mask:0x1
s_nop 0
s_waitcnt vmcnt(4)
buffer_load_dwordx4 v[108:111], v2, s[40:43], s65 offen offset:3072 nt
v_add_f32_dpp v18, v42, v41 row_ror:12 row_mask:0xf bank_mask:0x2
v_add_f32_dpp v19, v46, v45 row_ror:12 row_mask:0xf bank_mask:0x2
s_nop 0
v_add_f32_dpp v18, v43, v18 row_ror:8 row_mask:0xf bank_mask:0x2
v_add_f32_dpp v19, v47, v19 row_ror:8 row_mask:0xf bank_mask:0x2
s_nop 0
v_add_f32_dpp v18, v40, v18 row_ror:4 row_mask:0xf bank_mask:0x2
v_add_f32_dpp v19, v44, v19 row_ror:4 row_mask:0xf bank_mask:0x2
s_nop 0
s_add_u32 s65, s9, 1114112
s_waitcnt vmcnt(4)
buffer_load_dwordx4 v[112:115], v2, s[40:43], s65 offen offset:0 nt
v_add_f32_dpp v18, v51, v50 row_ror:12 row_mask:0xf bank_mask:0x4
v_add_f32_dpp v19, v55, v54 row_ror:12 row_mask:0xf bank_mask:0x4
s_nop 0
v_add_f32_dpp v18, v48, v18 row_ror:8 row_mask:0xf bank_mask:0x4
v_add_f32_dpp v19, v52, v19 row_ror:8 row_mask:0xf bank_mask:0x4
s_nop 0
v_add_f32_dpp v18, v49, v18 row_ror:4 row_mask:0xf bank_mask:0x4
v_add_f32_dpp v19, v53, v19 row_ror:4 row_mask:0xf bank_mask:0x4
s_nop 0
s_waitcnt vmcnt(4)
buffer_load_dwordx4 v[116:119], v2, s[40:43], s65 offen offset:1024 nt
v_add_f32_dpp v18, v56, v59 row_ror:12 row_mask:0xf bank_mask:0x8
v_add_f32_dpp v19, v60, v63 row_ror:12 row_mask:0xf bank_mask:0x8
s_nop 0
v_add_f32_dpp v18, v57, v18 row_ror:8 row_mask:0xf bank_mask:0x8
v_add_f32_dpp v19, v61, v19 row_ror:8 row_mask:0xf bank_mask:0x8
s_nop 0
v_add_f32_dpp v18, v58, v18 row_ror:4 row_mask:0xf bank_mask:0x8
v_add_f32_dpp v19, v62, v19 row_ror:4 row_mask:0xf bank_mask:0x8
s_nop 0
v_cvt_pk_bf16_f32 v15, 0, v18
v_cvt_pk_bf16_f32 v16, 0, v19
v_mul_f32 v15, s58, v15
v_mul_f32 v16, s58, v16
v_cvt_pk_bf16_f32 v12, v15, v16
v_cvt_pk_bf16_f32 v15, 0, v15
v_cvt_pk_bf16_f32 v16, 0, v16
v_max3_f32 v14, v14, v15, v16
s_waitcnt vmcnt(4)
buffer_load_dwordx4 v[120:123], v2, s[40:43], s65 offen offset:2048 nt
v_mfma_f32_16x16x32_bf16 v[32:35], v[192:195], v[4:7], 0
v_mfma_f32_16x16x32_bf16 v[36:39], v[196:199], v[4:7], 0
v_mfma_f32_16x16x32_bf16 v[40:43], v[200:203], v[4:7], 0
v_mfma_f32_16x16x32_bf16 v[44:47], v[204:207], v[4:7], 0
v_mfma_f32_16x16x32_bf16 v[48:51], v[208:211], v[4:7], 0
v_mfma_f32_16x16x32_bf16 v[52:55], v[212:215], v[4:7], 0
v_mfma_f32_16x16x32_bf16 v[56:59], v[216:219], v[4:7], 0
v_mfma_f32_16x16x32_bf16 v[60:63], v[220:223], v[4:7], 0
s_nop 1
v_add_f32_dpp v18, v33, v32 row_ror:12 row_mask:0xf bank_mask:0x1
v_add_f32_dpp v19, v37, v36 row_ror:12 row_mask:0xf bank_mask:0x1
s_nop 0
v_add_f32_dpp v18, v34, v18 row_ror:8 row_mask:0xf bank_mask:0x1
v_add_f32_dpp v19, v38, v19 row_ror:8 row_mask:0xf bank_mask:0x1
s_nop 0
v_add_f32_dpp v18, v35, v18 row_ror:4 row_mask:0xf bank_mask:0x1
v_add_f32_dpp v19, v39, v19 row_ror:4 row_mask:0xf bank_mask:0x1
s_nop 0
s_waitcnt vmcnt(4)
buffer_load_dwordx4 v[124:127], v2, s[40:43], s65 offen offset:3072 nt
v_mov_b32 v30, 9
ds_write_b32 v3, v30 offset:28416
v_add_f32_dpp v18, v42, v41 row_ror:12 row_mask:0xf bank_mask:0x2
v_add_f32_dpp v19, v46, v45 row_ror:12 row_mask:0xf bank_mask:0x2
s_nop 0
v_add_f32_dpp v18, v43, v18 row_ror:8 row_mask:0xf bank_mask:0x2
v_add_f32_dpp v19, v47, v19 row_ror:8 row_mask:0xf bank_mask:0x2
s_nop 0
v_add_f32_dpp v18, v40, v18 row_ror:4 row_mask:0xf bank_mask:0x2
v_add_f32_dpp v19, v44, v19 row_ror:4 row_mask:0xf bank_mask:0x2
s_nop 0
v_add_f32_dpp v18, v51, v50 row_ror:12 row_mask:0xf bank_mask:0x4
v_add_f32_dpp v19, v55, v54 row_ror:12 row_mask:0xf bank_mask:0x4
s_nop 0
v_add_f32_dpp v18, v48, v18 row_ror:8 row_mask:0xf bank_mask:0x4
v_add_f32_dpp v19, v52, v19 row_ror:8 row_mask:0xf bank_mask:0x4
s_nop 0
v_add_f32_dpp v18, v49, v18 row_ror:4 row_mask:0xf bank_mask:0x4
v_add_f32_dpp v19, v53, v19 row_ror:4 row_mask:0xf bank_mask:0x4
s_nop 0
s_add_u32 s65, s10, 1179648
s_waitcnt vmcnt(4)
buffer_load_dwordx4 v[128:131], v2, s[40:43], s65 offen offset:0 nt
v_add_f32_dpp v18, v56, v59 row_ror:12 row_mask:0xf bank_mask:0x8
v_add_f32_dpp v19, v60, v63 row_ror:12 row_mask:0xf bank_mask:0x8
s_nop 0
v_add_f32_dpp v18, v57, v18 row_ror:8 row_mask:0xf bank_mask:0x8
v_add_f32_dpp v19, v61, v19 row_ror:8 row_mask:0xf bank_mask:0x8
s_nop 0
v_add_f32_dpp v18, v58, v18 row_ror:4 row_mask:0xf bank_mask:0x8
v_add_f32_dpp v19, v62, v19 row_ror:4 row_mask:0xf bank_mask:0x8
s_nop 0
v_cvt_pk_bf16_f32 v15, 0, v18
v_cvt_pk_bf16_f32 v16, 0, v19
v_mul_f32 v15, s58, v15
v_mul_f32 v16, s58, v16
v_cvt_pk_bf16_f32 v13, v15, v16
v_cvt_pk_bf16_f32 v15, 0, v15
v_cvt_pk_bf16_f32 v16, 0, v16
v_max3_f32 v14, v14, v15, v16
s_waitcnt vmcnt(4)
buffer_load_dwordx4 v[132:135], v2, s[40:43], s65 offen offset:1024 nt
v_mfma_f32_16x16x32_bf16 v[32:35], v[224:227], v[4:7], 0
v_mfma_f32_16x16x32_bf16 v[36:39], v[228:231], v[4:7], 0
v_mfma_f32_16x16x32_bf16 v[40:43], v[232:235], v[4:7], 0
v_mfma_f32_16x16x32_bf16 v[44:47], v[236:239], v[4:7], 0
v_mfma_f32_16x16x32_bf16 v[48:51], v[240:243], v[4:7], 0
v_mfma_f32_16x16x32_bf16 v[52:55], v[244:247], v[4:7], 0
v_mfma_f32_16x16x32_bf16 v[56:59], v[248:251], v[4:7], 0
v_mfma_f32_16x16x32_bf16 v[60:63], v[252:255], v[4:7], 0
s_nop 1
v_add_f32_dpp v18, v33, v32 row_ror:12 row_mask:0xf bank_mask:0x1
v_add_f32_dpp v19, v37, v36 row_ror:12 row_mask:0xf bank_mask:0x1
s_nop 0
v_add_f32_dpp v18, v34, v18 row_ror:8 row_mask:0xf bank_mask:0x1
v_add_f32_dpp v19, v38, v19 row_ror:8 row_mask:0xf bank_mask:0x1
s_nop 0
v_add_f32_dpp v18, v35, v18 row_ror:4 row_mask:0xf bank_mask:0x1
v_add_f32_dpp v19, v39, v19 row_ror:4 row_mask:0xf bank_mask:0x1
s_nop 0
s_waitcnt vmcnt(4)
buffer_load_dwordx4 v[136:139], v2, s[40:43], s65 offen offset:2048 nt
v_add_f32_dpp v18, v42, v41 row_ror:12 row_mask:0xf bank_mask:0x2
v_add_f32_dpp v19, v46, v45 row_ror:12 row_mask:0xf bank_mask:0x2
s_nop 0
v_add_f32_dpp v18, v43, v18 row_ror:8 row_mask:0xf bank_mask:0x2
v_add_f32_dpp v19, v47, v19 row_ror:8 row_mask:0xf bank_mask:0x2
s_nop 0
v_add_f32_dpp v18, v40, v18 row_ror:4 row_mask:0xf bank_mask:0x2
v_add_f32_dpp v19, v44, v19 row_ror:4 row_mask:0xf bank_mask:0x2
s_nop 0
v_add_f32_dpp v18, v51, v50 row_ror:12 row_mask:0xf bank_mask:0x4
v_add_f32_dpp v19, v55, v54 row_ror:12 row_mask:0xf bank_mask:0x4
s_nop 0
v_add_f32_dpp v18, v48, v18 row_ror:8 row_mask:0xf bank_mask:0x4
v_add_f32_dpp v19, v52, v19 row_ror:8 row_mask:0xf bank_mask:0x4
s_nop 0
v_add_f32_dpp v18, v49, v18 row_ror:4 row_mask:0xf bank_mask:0x4
v_add_f32_dpp v19, v53, v19 row_ror:4 row_mask:0xf bank_mask:0x4
s_nop 0
s_waitcnt vmcnt(4)
buffer_load_dwordx4 v[140:143], v2, s[40:43], s65 offen offset:3072 nt
v_add_f32_dpp v18, v56, v59 row_ror:12 row_mask:0xf bank_mask:0x8
v_add_f32_dpp v19, v60, v63 row_ror:12 row_mask:0xf bank_mask:0x8
s_nop 0
v_add_f32_dpp v18, v57, v18 row_ror:8 row_mask:0xf bank_mask:0x8
v_add_f32_dpp v19, v61, v19 row_ror:8 row_mask:0xf bank_mask:0x8
s_nop 0
v_add_f32_dpp v18, v58, v18 row_ror:4 row_mask:0xf bank_mask:0x8
v_add_f32_dpp v19, v62, v19 row_ror:4 row_mask:0xf bank_mask:0x8
s_nop 0
v_cvt_pk_bf16_f32 v15, 0, v18
v_cvt_pk_bf16_f32 v16, 0, v19
v_mul_f32 v15, s58, v15
v_mul_f32 v16, s58, v16
v_cvt_pk_bf16_f32 v20, v15, v16
v_cvt_pk_bf16_f32 v15, 0, v15
v_cvt_pk_bf16_f32 v16, 0, v16
v_max3_f32 v14, v14, v15, v16
s_add_u32 s65, s11, 1245184
s_waitcnt vmcnt(4)
buffer_load_dwordx4 v[144:147], v2, s[40:43], s65 offen offset:0 nt
v_mfma_f32_16x16x32_bf16 v[32:35], v[64:67], v[4:7], 0
v_mfma_f32_16x16x32_bf16 v[36:39], v[68:71], v[4:7], 0
v_mfma_f32_16x16x32_bf16 v[40:43], v[72:75], v[4:7], 0
v_mfma_f32_16x16x32_bf16 v[44:47], v[76:79], v[4:7], 0
v_mfma_f32_16x16x32_bf16 v[48:51], v[80:83], v[4:7], 0
v_mfma_f32_16x16x32_bf16 v[52:55], v[84:87], v[4:7], 0
v_mfma_f32_16x16x32_bf16 v[56:59], v[88:91], v[4:7], 0
v_mfma_f32_16x16x32_bf16 v[60:63], v[92:95], v[4:7], 0
s_nop 1
v_add_f32_dpp v18, v33, v32 row_ror:12 row_mask:0xf bank_mask:0x1
v_add_f32_dpp v19, v37, v36 row_ror:12 row_mask:0xf bank_mask:0x1
s_nop 0
v_add_f32_dpp v18, v34, v18 row_ror:8 row_mask:0xf bank_mask:0x1
v_add_f32_dpp v19, v38, v19 row_ror:8 row_mask:0xf bank_mask:0x1
s_nop 0
v_add_f32_dpp v18, v35, v18 row_ror:4 row_mask:0xf bank_mask:0x1
v_add_f32_dpp v19, v39, v19 row_ror:4 row_mask:0xf bank_mask:0x1
s_nop 0
s_waitcnt vmcnt(4)
buffer_load_dwordx4 v[148:151], v2, s[40:43], s65 offen offset:1024 nt
v_add_f32_dpp v18, v42, v41 row_ror:12 row_mask:0xf bank_mask:0x2
v_add_f32_dpp v19, v46, v45 row_ror:12 row_mask:0xf bank_mask:0x2
s_nop 0
v_add_f32_dpp v18, v43, v18 row_ror:8 row_mask:0xf bank_mask:0x2
v_add_f32_dpp v19, v47, v19 row_ror:8 row_mask:0xf bank_mask:0x2
s_nop 0
v_add_f32_dpp v18, v40, v18 row_ror:4 row_mask:0xf bank_mask:0x2
v_add_f32_dpp v19, v44, v19 row_ror:4 row_mask:0xf bank_mask:0x2
s_nop 0
v_add_f32_dpp v18, v51, v50 row_ror:12 row_mask:0xf bank_mask:0x4
v_add_f32_dpp v19, v55, v54 row_ror:12 row_mask:0xf bank_mask:0x4
s_nop 0
v_add_f32_dpp v18, v48, v18 row_ror:8 row_mask:0xf bank_mask:0x4
v_add_f32_dpp v19, v52, v19 row_ror:8 row_mask:0xf bank_mask:0x4
s_nop 0
v_add_f32_dpp v18, v49, v18 row_ror:4 row_mask:0xf bank_mask:0x4
v_add_f32_dpp v19, v53, v19 row_ror:4 row_mask:0xf bank_mask:0x4
s_nop 0
s_waitcnt vmcnt(4)
buffer_load_dwordx4 v[152:155], v2, s[40:43], s65 offen offset:2048 nt
v_add_f32_dpp v18, v56, v59 row_ror:12 row_mask:0xf bank_mask:0x8
v_add_f32_dpp v19, v60, v63 row_ror:12 row_mask:0xf bank_mask:0x8
s_nop 0
v_add_f32_dpp v18, v57, v18 row_ror:8 row_mask:0xf bank_mask:0x8
v_add_f32_dpp v19, v61, v19 row_ror:8 row_mask:0xf bank_mask:0x8
s_nop 0
v_add_f32_dpp v18, v58, v18 row_ror:4 row_mask:0xf bank_mask:0x8
v_add_f32_dpp v19, v62, v19 row_ror:4 row_mask:0xf bank_mask:0x8
s_nop 0
v_cvt_pk_bf16_f32 v15, 0, v18
v_cvt_pk_bf16_f32 v16, 0, v19
v_mul_f32 v15, s58, v15
v_mul_f32 v16, s58, v16
v_cvt_pk_bf16_f32 v21, v15, v16
v_cvt_pk_bf16_f32 v15, 0, v15
v_cvt_pk_bf16_f32 v16, 0, v16
v_max3_f32 v14, v14, v15, v16
s_waitcnt vmcnt(4)
buffer_load_dwordx4 v[156:159], v2, s[40:43], s65 offen offset:3072 nt
v_mov_b32 v30, 10
ds_write_b32 v3, v30 offset:28416
v_mov_b32 v236, 0
v_mov_b32 v237, 0
v_mov_b32 v239, 0
v_mov_b32 v240, 1
v_mfma_f32_16x16x32_bf16 v[32:35], v[96:99], v[4:7], 0
v_mfma_f32_16x16x32_bf16 v[36:39], v[100:103], v[4:7], 0
v_mfma_f32_16x16x32_bf16 v[40:43], v[104:107], v[4:7], 0
v_mfma_f32_16x16x32_bf16 v[44:47], v[108:111], v[4:7], 0
v_mfma_f32_16x16x32_bf16 v[48:51], v[112:115], v[4:7], 0
v_mfma_f32_16x16x32_bf16 v[52:55], v[116:119], v[4:7], 0
v_mfma_f32_16x16x32_bf16 v[56:59], v[120:123], v[4:7], 0
v_mfma_f32_16x16x32_bf16 v[60:63], v[124:127], v[4:7], 0
s_nop 1
s_add_u32 s65, s8, 1310720
s_waitcnt vmcnt(4)
buffer_load_dwordx4 v[64:67], v2, s[40:43], s65 offen offset:0 nt
v_add_f32_dpp v18, v33, v32 row_ror:12 row_mask:0xf bank_mask:0x1
v_add_f32_dpp v19, v37, v36 row_ror:12 row_mask:0xf bank_mask:0x1
s_nop 0
v_add_f32_dpp v18, v34, v18 row_ror:8 row_mask:0xf bank_mask:0x1
v_add_f32_dpp v19, v38, v19 row_ror:8 row_mask:0xf bank_mask:0x1
s_nop 0
v_add_f32_dpp v18, v35, v18 row_ror:4 row_mask:0xf bank_mask:0x1
v_add_f32_dpp v19, v39, v19 row_ror:4 row_mask:0xf bank_mask:0x1
s_nop 0
s_waitcnt vmcnt(4)
buffer_load_dwordx4 v[68:71], v2, s[40:43], s65 offen offset:1024 nt
s_waitcnt vmcnt(4)
buffer_load_dwordx4 v[72:75], v2, s[40:43], s65 offen offset:2048 nt
v_add_f32_dpp v18, v42, v41 row_ror:12 row_mask:0xf bank_mask:0x2
v_add_f32_dpp v19, v46, v45 row_ror:12 row_mask:0xf bank_mask:0x2
s_nop 0
v_add_f32_dpp v18, v43, v18 row_ror:8 row_mask:0xf bank_mask:0x2
v_add_f32_dpp v19, v47, v19 row_ror:8 row_mask:0xf bank_mask:0x2
s_nop 0
v_add_f32_dpp v18, v40, v18 row_ror:4 row_mask:0xf bank_mask:0x2
v_add_f32_dpp v19, v44, v19 row_ror:4 row_mask:0xf bank_mask:0x2
s_nop 0
s_waitcnt vmcnt(4)
buffer_load_dwordx4 v[76:79], v2, s[40:43], s65 offen offset:3072 nt
v_add_f32_dpp v18, v51, v50 row_ror:12 row_mask:0xf bank_mask:0x4
v_add_f32_dpp v19, v55, v54 row_ror:12 row_mask:0xf bank_mask:0x4
s_nop 0
v_add_f32_dpp v18, v48, v18 row_ror:8 row_mask:0xf bank_mask:0x4
v_add_f32_dpp v19, v52, v19 row_ror:8 row_mask:0xf bank_mask:0x4
s_nop 0
v_add_f32_dpp v18, v49, v18 row_ror:4 row_mask:0xf bank_mask:0x4
v_add_f32_dpp v19, v53, v19 row_ror:4 row_mask:0xf bank_mask:0x4
s_nop 0
s_add_u32 s65, s9, 1376256
s_waitcnt vmcnt(4)
buffer_load_dwordx4 v[80:83], v2, s[40:43], s65 offen offset:0 nt
s_waitcnt vmcnt(4)
buffer_load_dwordx4 v[84:87], v2, s[40:43], s65 offen offset:1024 nt
v_add_f32_dpp v18, v56, v59 row_ror:12 row_mask:0xf bank_mask:0x8
v_add_f32_dpp v19, v60, v63 row_ror:12 row_mask:0xf bank_mask:0x8
s_nop 0
v_add_f32_dpp v18, v57, v18 row_ror:8 row_mask:0xf bank_mask:0x8
v_add_f32_dpp v19, v61, v19 row_ror:8 row_mask:0xf bank_mask:0x8
s_nop 0
v_add_f32_dpp v18, v58, v18 row_ror:4 row_mask:0xf bank_mask:0x8
v_add_f32_dpp v19, v62, v19 row_ror:4 row_mask:0xf bank_mask:0x8
s_nop 0
v_cvt_pk_bf16_f32 v15, 0, v18
v_cvt_pk_bf16_f32 v16, 0, v19
v_mul_f32 v15, s58, v15
v_mul_f32 v16, s58, v16
v_cvt_pk_bf16_f32 v22, v15, v16
v_cvt_pk_bf16_f32 v15, 0, v15
v_cvt_pk_bf16_f32 v16, 0, v16
v_max3_f32 v14, v14, v15, v16
s_waitcnt vmcnt(4)
buffer_load_dwordx4 v[88:91], v2, s[40:43], s65 offen offset:2048 nt
s_waitcnt vmcnt(4)
buffer_load_dwordx4 v[92:95], v2, s[40:43], s65 offen offset:3072 nt
v_mov_b32 v30, 11
ds_write_b32 v3, v30 offset:28416
v_mfma_f32_16x16x32_bf16 v[32:35], v[128:131], v[4:7], 0
v_mfma_f32_16x16x32_bf16 v[36:39], v[132:135], v[4:7], 0
v_mfma_f32_16x16x32_bf16 v[40:43], v[136:139], v[4:7], 0
v_mfma_f32_16x16x32_bf16 v[44:47], v[140:143], v[4:7], 0
v_mfma_f32_16x16x32_bf16 v[48:51], v[144:147], v[4:7], 0
v_mfma_f32_16x16x32_bf16 v[52:55], v[148:151], v[4:7], 0
v_mfma_f32_16x16x32_bf16 v[56:59], v[152:155], v[4:7], 0
v_mfma_f32_16x16x32_bf16 v[60:63], v[156:159], v[4:7], 0
s_nop 1
s_add_u32 s65, s10, 1441792
s_waitcnt vmcnt(4)
buffer_load_dwordx4 v[96:99], v2, s[40:43], s65 offen offset:0 nt
v_add_f32_dpp v18, v33, v32 row_ror:12 row_mask:0xf bank_mask:0x1
v_add_f32_dpp v19, v37, v36 row_ror:12 row_mask:0xf bank_mask:0x1
s_nop 0
v_add_f32_dpp v18, v34, v18 row_ror:8 row_mask:0xf bank_mask:0x1
v_add_f32_dpp v19, v38, v19 row_ror:8 row_mask:0xf bank_mask:0x1
s_nop 0
v_add_f32_dpp v18, v35, v18 row_ror:4 row_mask:0xf bank_mask:0x1
v_add_f32_dpp v19, v39, v19 row_ror:4 row_mask:0xf bank_mask:0x1
s_nop 0
s_waitcnt vmcnt(4)
buffer_load_dwordx4 v[100:103], v2, s[40:43], s65 offen offset:1024 nt
s_waitcnt vmcnt(4)
buffer_load_dwordx4 v[104:107], v2, s[40:43], s65 offen offset:2048 nt
v_add_f32_dpp v18, v42, v41 row_ror:12 row_mask:0xf bank_mask:0x2
v_add_f32_dpp v19, v46, v45 row_ror:12 row_mask:0xf bank_mask:0x2
s_nop 0
v_add_f32_dpp v18, v43, v18 row_ror:8 row_mask:0xf bank_mask:0x2
v_add_f32_dpp v19, v47, v19 row_ror:8 row_mask:0xf bank_mask:0x2
s_nop 0
v_add_f32_dpp v18, v40, v18 row_ror:4 row_mask:0xf bank_mask:0x2
v_add_f32_dpp v19, v44, v19 row_ror:4 row_mask:0xf bank_mask:0x2
s_nop 0
s_waitcnt vmcnt(4)
buffer_load_dwordx4 v[108:111], v2, s[40:43], s65 offen offset:3072 nt
v_add_f32_dpp v18, v51, v50 row_ror:12 row_mask:0xf bank_mask:0x4
v_add_f32_dpp v19, v55, v54 row_ror:12 row_mask:0xf bank_mask:0x4
s_nop 0
v_add_f32_dpp v18, v48, v18 row_ror:8 row_mask:0xf bank_mask:0x4
v_add_f32_dpp v19, v52, v19 row_ror:8 row_mask:0xf bank_mask:0x4
s_nop 0
v_add_f32_dpp v18, v49, v18 row_ror:4 row_mask:0xf bank_mask:0x4
v_add_f32_dpp v19, v53, v19 row_ror:4 row_mask:0xf bank_mask:0x4
s_nop 0
s_add_u32 s65, s11, 1507328
s_waitcnt vmcnt(4)
buffer_load_dwordx4 v[112:115], v2, s[40:43], s65 offen offset:0 nt
s_waitcnt vmcnt(4)
buffer_load_dwordx4 v[116:119], v2, s[40:43], s65 offen offset:1024 nt
v_add_f32_dpp v18, v56, v59 row_ror:12 row_mask:0xf bank_mask:0x8
v_add_f32_dpp v19, v60, v63 row_ror:12 row_mask:0xf bank_mask:0x8
s_nop 0
v_add_f32_dpp v18, v57, v18 row_ror:8 row_mask:0xf bank_mask:0x8
v_add_f32_dpp v19, v61, v19 row_ror:8 row_mask:0xf bank_mask:0x8
s_nop 0
v_add_f32_dpp v18, v58, v18 row_ror:4 row_mask:0xf bank_mask:0x8
v_add_f32_dpp v19, v62, v19 row_ror:4 row_mask:0xf bank_mask:0x8
s_nop 0
v_cvt_pk_bf16_f32 v15, 0, v18
v_cvt_pk_bf16_f32 v16, 0, v19
v_mul_f32 v15, s58, v15
v_mul_f32 v16, s58, v16
v_cvt_pk_bf16_f32 v23, v15, v16
v_cvt_pk_bf16_f32 v15, 0, v15
v_cvt_pk_bf16_f32 v16, 0, v16
v_max3_f32 v14, v14, v15, v16
s_waitcnt vmcnt(4)
buffer_load_dwordx4 v[120:123], v2, s[40:43], s65 offen offset:2048 nt
s_waitcnt vmcnt(4)
buffer_load_dwordx4 v[124:127], v2, s[40:43], s65 offen offset:3072 nt
v_mov_b32 v30, 12
ds_write_b32 v3, v30 offset:28416
v_mfma_f32_16x16x32_bf16 v[32:35], v[64:67], v[4:7], 0
v_mfma_f32_16x16x32_bf16 v[36:39], v[68:71], v[4:7], 0
v_mfma_f32_16x16x32_bf16 v[40:43], v[72:75], v[4:7], 0
v_mfma_f32_16x16x32_bf16 v[44:47], v[76:79], v[4:7], 0
v_mfma_f32_16x16x32_bf16 v[48:51], v[80:83], v[4:7], 0
v_mfma_f32_16x16x32_bf16 v[52:55], v[84:87], v[4:7], 0
v_mfma_f32_16x16x32_bf16 v[56:59], v[88:91], v[4:7], 0
v_mfma_f32_16x16x32_bf16 v[60:63], v[92:95], v[4:7], 0
s_nop 1
s_add_u32 s65, s8, 1572864
s_waitcnt lgkmcnt(0)
v_cmp_eq_u32 vcc, 1, v236
v_readfirstlane_b32 s14, v236
ds_read_b32 v236, v237 offset:29468
s_waitcnt vmcnt(7)
s_cbranch_vccnz L_bo_41
s_waitcnt vmcnt(5)
s_cmp_eq_u32 s14, 3
s_cbranch_scc1 L_bo_41
s_waitcnt vmcnt(4)
L_bo_41:
buffer_load_dwordx4 v[128:131], v2, s[40:43], s65 offen offset:0 nt
v_add_f32_dpp v18, v33, v32 row_ror:12 row_mask:0xf bank_mask:0x1
v_add_f32_dpp v19, v37, v36 row_ror:12 row_mask:0xf bank_mask:0x1
s_nop 0
v_add_f32_dpp v18, v34, v18 row_ror:8 row_mask:0xf bank_mask:0x1
v_add_f32_dpp v19, v38, v19 row_ror:8 row_mask:0xf bank_mask:0x1
s_nop 0
v_add_f32_dpp v18, v35, v18 row_ror:4 row_mask:0xf bank_mask:0x1
v_add_f32_dpp v19, v39, v19 row_ror:4 row_mask:0xf bank_mask:0x1
s_nop 0
s_waitcnt vmcnt(7)
s_cbranch_vccnz L_bo_42
s_waitcnt vmcnt(5)
s_cmp_eq_u32 s14, 3
s_cbranch_scc1 L_bo_42
s_waitcnt vmcnt(4)
L_bo_42:
buffer_load_dwordx4 v[132:135], v2, s[40:43], s65 offen offset:1024 nt
s_waitcnt vmcnt(7)
s_cbranch_vccnz L_bo_43
s_waitcnt vmcnt(5)
s_cmp_eq_u32 s14, 3
s_cbranch_scc1 L_bo_43
s_waitcnt vmcnt(4)
L_bo_43:
buffer_load_dwordx4 v[136:139], v2, s[40:43], s65 offen offset:2048 nt
v_add_f32_dpp v18, v42, v41 row_ror:12 row_mask:0xf bank_mask:0x2
v_add_f32_dpp v19, v46, v45 row_ror:12 row_mask:0xf bank_mask:0x2
s_nop 0
v_add_f32_dpp v18, v43, v18 row_ror:8 row_mask:0xf bank_mask:0x2
v_add_f32_dpp v19, v47, v19 row_ror:8 row_mask:0xf bank_mask:0x2
s_nop 0
v_add_f32_dpp v18, v40, v18 row_ror:4 row_mask:0xf bank_mask:0x2
v_add_f32_dpp v19, v44, v19 row_ror:4 row_mask:0xf bank_mask:0x2
s_nop 0
s_waitcnt vmcnt(7)
s_cbranch_vccnz L_bo_44
s_waitcnt vmcnt(5)
s_cmp_eq_u32 s14, 3
s_cbranch_scc1 L_bo_44
s_waitcnt vmcnt(4)
L_bo_44:
buffer_load_dwordx4 v[140:143], v2, s[40:43], s65 offen offset:3072 nt
v_add_f32_dpp v18, v51, v50 row_ror:12 row_mask:0xf bank_mask:0x4
v_add_f32_dpp v19, v55, v54 row_ror:12 row_mask:0xf bank_mask:0x4
s_nop 0
v_add_f32_dpp v18, v48, v18 row_ror:8 row_mask:0xf bank_mask:0x4
v_add_f32_dpp v19, v52, v19 row_ror:8 row_mask:0xf bank_mask:0x4
s_nop 0
v_add_f32_dpp v18, v49, v18 row_ror:4 row_mask:0xf bank_mask:0x4
v_add_f32_dpp v19, v53, v19 row_ror:4 row_mask:0xf bank_mask:0x4
s_nop 0
s_add_u32 s65, s9, 1638400
s_waitcnt lgkmcnt(0)
v_cmp_eq_u32 vcc, 1, v236
v_readfirstlane_b32 s14, v236
ds_read_b32 v236, v237 offset:29468
s_waitcnt vmcnt(7)
s_cbranch_vccnz L_bo_45
s_waitcnt vmcnt(5)
s_cmp_eq_u32 s14, 3
s_cbranch_scc1 L_bo_45
s_waitcnt vmcnt(4)
L_bo_45:
buffer_load_dwordx4 v[144:147], v2, s[40:43], s65 offen offset:0 nt
s_waitcnt vmcnt(7)
s_cbranch_vccnz L_bo_46
s_waitcnt vmcnt(5)
s_cmp_eq_u32 s14, 3
s_cbranch_scc1 L_bo_46
s_waitcnt vmcnt(4)
L_bo_46:
buffer_load_dwordx4 v[148:151], v2, s[40:43], s65 offen offset:1024 nt
v_add_f32_dpp v18, v56, v59 row_ror:12 row_mask:0xf bank_mask:0x8
v_add_f32_dpp v19, v60, v63 row_ror:12 row_mask:0xf bank_mask:0x8
s_nop 0
v_add_f32_dpp v18, v57, v18 row_ror:8 row_mask:0xf bank_mask:0x8
v_add_f32_dpp v19, v61, v19 row_ror:8 row_mask:0xf bank_mask:0x8
s_nop 0
v_add_f32_dpp v18, v58, v18 row_ror:4 row_mask:0xf bank_mask:0x8
v_add_f32_dpp v19, v62, v19 row_ror:4 row_mask:0xf bank_mask:0x8
s_nop 0
v_cvt_pk_bf16_f32 v15, 0, v18
v_cvt_pk_bf16_f32 v16, 0, v19
v_mul_f32 v15, s58, v15
v_mul_f32 v16, s58, v16
v_cvt_pk_bf16_f32 v25, v15, v16
v_cvt_pk_bf16_f32 v15, 0, v15
v_cvt_pk_bf16_f32 v16, 0, v16
v_max3_f32 v14, v14, v15, v16
s_waitcnt vmcnt(7)
s_cbranch_vccnz L_bo_47
s_waitcnt vmcnt(5)
s_cmp_eq_u32 s14, 3
s_cbranch_scc1 L_bo_47
s_waitcnt vmcnt(4)
L_bo_47:
buffer_load_dwordx4 v[152:155], v2, s[40:43], s65 offen offset:2048 nt
s_waitcnt vmcnt(7)
s_cbranch_vccnz L_bo_48
s_waitcnt vmcnt(5)
s_cmp_eq_u32 s14, 3
s_cbranch_scc1 L_bo_48
s_waitcnt vmcnt(4)
L_bo_48:
buffer_load_dwordx4 v[156:159], v2, s[40:43], s65 offen offset:3072 nt
v_mov_b32 v30, 13
ds_write_b32 v3, v30 offset:28416
v_mfma_f32_16x16x32_bf16 v[32:35], v[96:99], v[4:7], 0
v_mfma_f32_16x16x32_bf16 v[36:39], v[100:103], v[4:7], 0
v_mfma_f32_16x16x32_bf16 v[40:43], v[104:107], v[4:7], 0
v_mfma_f32_16x16x32_bf16 v[44:47], v[108:111], v[4:7], 0
v_mfma_f32_16x16x32_bf16 v[48:51], v[112:115], v[4:7], 0
v_mfma_f32_16x16x32_bf16 v[52:55], v[116:119], v[4:7], 0
v_mfma_f32_16x16x32_bf16 v[56:59], v[120:123], v[4:7], 0
v_mfma_f32_16x16x32_bf16 v[60:63], v[124:127], v[4:7], 0
s_nop 1
s_add_u32 s65, s10, 1703936
s_waitcnt lgkmcnt(0)
v_cmp_eq_u32 vcc, 1, v236
v_readfirstlane_b32 s14, v236
ds_read_b32 v236, v237 offset:29468
s_waitcnt vmcnt(7)
s_cbranch_vccnz L_bo_49
s_waitcnt vmcnt(5)
s_cmp_eq_u32 s14, 3
s_cbranch_scc1 L_bo_49
s_waitcnt vmcnt(4)
L_bo_49:
buffer_load_dwordx4 v[64:67], v2, s[40:43], s65 offen offset:0 nt
v_add_f32_dpp v18, v33, v32 row_ror:12 row_mask:0xf bank_mask:0x1
v_add_f32_dpp v19, v37, v36 row_ror:12 row_mask:0xf bank_mask:0x1
s_nop 0
v_add_f32_dpp v18, v34, v18 row_ror:8 row_mask:0xf bank_mask:0x1
v_add_f32_dpp v19, v38, v19 row_ror:8 row_mask:0xf bank_mask:0x1
s_nop 0
v_add_f32_dpp v18, v35, v18 row_ror:4 row_mask:0xf bank_mask:0x1
v_add_f32_dpp v19, v39, v19 row_ror:4 row_mask:0xf bank_mask:0x1
s_nop 0
s_waitcnt vmcnt(7)
s_cbranch_vccnz L_bo_50
s_waitcnt vmcnt(5)
s_cmp_eq_u32 s14, 3
s_cbranch_scc1 L_bo_50
s_waitcnt vmcnt(4)
L_bo_50:
buffer_load_dwordx4 v[68:71], v2, s[40:43], s65 offen offset:1024 nt
s_waitcnt vmcnt(7)
s_cbranch_vccnz L_bo_51
s_waitcnt vmcnt(5)
s_cmp_eq_u32 s14, 3
s_cbranch_scc1 L_bo_51
s_waitcnt vmcnt(4)
L_bo_51:
buffer_load_dwordx4 v[72:75], v2, s[40:43], s65 offen offset:2048 nt
v_add_f32_dpp v18, v42, v41 row_ror:12 row_mask:0xf bank_mask:0x2
v_add_f32_dpp v19, v46, v45 row_ror:12 row_mask:0xf bank_mask:0x2
s_nop 0
v_add_f32_dpp v18, v43, v18 row_ror:8 row_mask:0xf bank_mask:0x2
v_add_f32_dpp v19, v47, v19 row_ror:8 row_mask:0xf bank_mask:0x2
s_nop 0
v_add_f32_dpp v18, v40, v18 row_ror:4 row_mask:0xf bank_mask:0x2
v_add_f32_dpp v19, v44, v19 row_ror:4 row_mask:0xf bank_mask:0x2
s_nop 0
s_waitcnt vmcnt(7)
s_cbranch_vccnz L_bo_52
s_waitcnt vmcnt(5)
s_cmp_eq_u32 s14, 3
s_cbranch_scc1 L_bo_52
s_waitcnt vmcnt(4)
L_bo_52:
buffer_load_dwordx4 v[76:79], v2, s[40:43], s65 offen offset:3072 nt
v_add_f32_dpp v18, v51, v50 row_ror:12 row_mask:0xf bank_mask:0x4
v_add_f32_dpp v19, v55, v54 row_ror:12 row_mask:0xf bank_mask:0x4
s_nop 0
v_add_f32_dpp v18, v48, v18 row_ror:8 row_mask:0xf bank_mask:0x4
v_add_f32_dpp v19, v52, v19 row_ror:8 row_mask:0xf bank_mask:0x4
s_nop 0
v_add_f32_dpp v18, v49, v18 row_ror:4 row_mask:0xf bank_mask:0x4
v_add_f32_dpp v19, v53, v19 row_ror:4 row_mask:0xf bank_mask:0x4
s_nop 0
s_add_u32 s65, s11, 1769472
s_waitcnt lgkmcnt(0)
v_cmp_eq_u32 vcc, 1, v236
v_readfirstlane_b32 s14, v236
ds_read_b32 v236, v237 offset:29468
s_waitcnt vmcnt(7)
s_cbranch_vccnz L_bo_53
s_waitcnt vmcnt(5)
s_cmp_eq_u32 s14, 3
s_cbranch_scc1 L_bo_53
s_waitcnt vmcnt(4)
L_bo_53:
buffer_load_dwordx4 v[80:83], v2, s[40:43], s65 offen offset:0 nt
s_waitcnt vmcnt(7)
s_cbranch_vccnz L_bo_54
s_waitcnt vmcnt(5)
s_cmp_eq_u32 s14, 3
s_cbranch_scc1 L_bo_54
s_waitcnt vmcnt(4)
L_bo_54:
buffer_load_dwordx4 v[84:87], v2, s[40:43], s65 offen offset:1024 nt
v_add_f32_dpp v18, v56, v59 row_ror:12 row_mask:0xf bank_mask:0x8
v_add_f32_dpp v19, v60, v63 row_ror:12 row_mask:0xf bank_mask:0x8
s_nop 0
v_add_f32_dpp v18, v57, v18 row_ror:8 row_mask:0xf bank_mask:0x8
v_add_f32_dpp v19, v61, v19 row_ror:8 row_mask:0xf bank_mask:0x8
s_nop 0
v_add_f32_dpp v18, v58, v18 row_ror:4 row_mask:0xf bank_mask:0x8
v_add_f32_dpp v19, v62, v19 row_ror:4 row_mask:0xf bank_mask:0x8
s_nop 0
v_cvt_pk_bf16_f32 v15, 0, v18
v_cvt_pk_bf16_f32 v16, 0, v19
v_mul_f32 v15, s58, v15
v_mul_f32 v16, s58, v16
v_cvt_pk_bf16_f32 v26, v15, v16
v_cvt_pk_bf16_f32 v15, 0, v15
v_cvt_pk_bf16_f32 v16, 0, v16
v_max3_f32 v14, v14, v15, v16
s_waitcnt vmcnt(7)
s_cbranch_vccnz L_bo_55
s_waitcnt vmcnt(5)
s_cmp_eq_u32 s14, 3
s_cbranch_scc1 L_bo_55
s_waitcnt vmcnt(4)
L_bo_55:
buffer_load_dwordx4 v[88:91], v2, s[40:43], s65 offen offset:2048 nt
s_waitcnt vmcnt(7)
s_cbranch_vccnz L_bo_56
s_waitcnt vmcnt(5)
s_cmp_eq_u32 s14, 3
s_cbranch_scc1 L_bo_56
s_waitcnt vmcnt(4)
L_bo_56:
buffer_load_dwordx4 v[92:95], v2, s[40:43], s65 offen offset:3072 nt
v_mov_b32 v30, 14
ds_write_b32 v3, v30 offset:28416
v_mfma_f32_16x16x32_bf16 v[32:35], v[128:131], v[4:7], 0
v_mfma_f32_16x16x32_bf16 v[36:39], v[132:135], v[4:7], 0
v_mfma_f32_16x16x32_bf16 v[40:43], v[136:139], v[4:7], 0
v_mfma_f32_16x16x32_bf16 v[44:47], v[140:143], v[4:7], 0
v_mfma_f32_16x16x32_bf16 v[48:51], v[144:147], v[4:7], 0
v_mfma_f32_16x16x32_bf16 v[52:55], v[148:151], v[4:7], 0
v_mfma_f32_16x16x32_bf16 v[56:59], v[152:155], v[4:7], 0
v_mfma_f32_16x16x32_bf16 v[60:63], v[156:159], v[4:7], 0
s_nop 1
s_add_u32 s65, s8, 1835008
s_waitcnt lgkmcnt(0)
v_cmp_eq_u32 vcc, 1, v236
v_readfirstlane_b32 s14, v236
ds_read_b32 v236, v237 offset:29468
s_waitcnt vmcnt(7)
s_cbranch_vccnz L_bo_57
s_waitcnt vmcnt(5)
s_cmp_eq_u32 s14, 3
s_cbranch_scc1 L_bo_57
s_waitcnt vmcnt(4)
L_bo_57:
buffer_load_dwordx4 v[96:99], v2, s[40:43], s65 offen offset:0 nt
v_add_f32_dpp v18, v33, v32 row_ror:12 row_mask:0xf bank_mask:0x1
v_add_f32_dpp v19, v37, v36 row_ror:12 row_mask:0xf bank_mask:0x1
s_nop 0
v_add_f32_dpp v18, v34, v18 row_ror:8 row_mask:0xf bank_mask:0x1
v_add_f32_dpp v19, v38, v19 row_ror:8 row_mask:0xf bank_mask:0x1
s_nop 0
v_add_f32_dpp v18, v35, v18 row_ror:4 row_mask:0xf bank_mask:0x1
v_add_f32_dpp v19, v39, v19 row_ror:4 row_mask:0xf bank_mask:0x1
s_nop 0
s_waitcnt vmcnt(7)
s_cbranch_vccnz L_bo_58
s_waitcnt vmcnt(5)
s_cmp_eq_u32 s14, 3
s_cbranch_scc1 L_bo_58
s_waitcnt vmcnt(4)
L_bo_58:
buffer_load_dwordx4 v[100:103], v2, s[40:43], s65 offen offset:1024 nt
s_waitcnt vmcnt(7)
s_cbranch_vccnz L_bo_59
s_waitcnt vmcnt(5)
s_cmp_eq_u32 s14, 3
s_cbranch_scc1 L_bo_59
s_waitcnt vmcnt(4)
L_bo_59:
buffer_load_dwordx4 v[104:107], v2, s[40:43], s65 offen offset:2048 nt
v_add_f32_dpp v18, v42, v41 row_ror:12 row_mask:0xf bank_mask:0x2
v_add_f32_dpp v19, v46, v45 row_ror:12 row_mask:0xf bank_mask:0x2
s_nop 0
v_add_f32_dpp v18, v43, v18 row_ror:8 row_mask:0xf bank_mask:0x2
v_add_f32_dpp v19, v47, v19 row_ror:8 row_mask:0xf bank_mask:0x2
s_nop 0
v_add_f32_dpp v18, v40, v18 row_ror:4 row_mask:0xf bank_mask:0x2
v_add_f32_dpp v19, v44, v19 row_ror:4 row_mask:0xf bank_mask:0x2
s_nop 0
s_waitcnt vmcnt(7)
s_cbranch_vccnz L_bo_60
s_waitcnt vmcnt(5)
s_cmp_eq_u32 s14, 3
s_cbranch_scc1 L_bo_60
s_waitcnt vmcnt(4)
L_bo_60:
buffer_load_dwordx4 v[108:111], v2, s[40:43], s65 offen offset:3072 nt
v_add_f32_dpp v18, v51, v50 row_ror:12 row_mask:0xf bank_mask:0x4
v_add_f32_dpp v19, v55, v54 row_ror:12 row_mask:0xf bank_mask:0x4
s_nop 0
v_add_f32_dpp v18, v48, v18 row_ror:8 row_mask:0xf bank_mask:0x4
v_add_f32_dpp v19, v52, v19 row_ror:8 row_mask:0xf bank_mask:0x4
s_nop 0
v_add_f32_dpp v18, v49, v18 row_ror:4 row_mask:0xf bank_mask:0x4
v_add_f32_dpp v19, v53, v19 row_ror:4 row_mask:0xf bank_mask:0x4
s_nop 0
s_add_u32 s65, s9, 1900544
s_waitcnt lgkmcnt(0)
v_cmp_eq_u32 vcc, 1, v236
v_readfirstlane_b32 s14, v236
ds_read_b32 v236, v237 offset:29468
s_waitcnt vmcnt(7)
s_cbranch_vccnz L_bo_61
s_waitcnt vmcnt(5)
s_cmp_eq_u32 s14, 3
s_cbranch_scc1 L_bo_61
s_waitcnt vmcnt(4)
L_bo_61:
buffer_load_dwordx4 v[112:115], v2, s[40:43], s65 offen offset:0 nt
s_waitcnt vmcnt(7)
s_cbranch_vccnz L_bo_62
s_waitcnt vmcnt(5)
s_cmp_eq_u32 s14, 3
s_cbranch_scc1 L_bo_62
s_waitcnt vmcnt(4)
L_bo_62:
buffer_load_dwordx4 v[116:119], v2, s[40:43], s65 offen offset:1024 nt
v_add_f32_dpp v18, v56, v59 row_ror:12 row_mask:0xf bank_mask:0x8
v_add_f32_dpp v19, v60, v63 row_ror:12 row_mask:0xf bank_mask:0x8
s_nop 0
v_add_f32_dpp v18, v57, v18 row_ror:8 row_mask:0xf bank_mask:0x8
v_add_f32_dpp v19, v61, v19 row_ror:8 row_mask:0xf bank_mask:0x8
s_nop 0
v_add_f32_dpp v18, v58, v18 row_ror:4 row_mask:0xf bank_mask:0x8
v_add_f32_dpp v19, v62, v19 row_ror:4 row_mask:0xf bank_mask:0x8
s_nop 0
v_cvt_pk_bf16_f32 v15, 0, v18
v_cvt_pk_bf16_f32 v16, 0, v19
v_mul_f32 v15, s58, v15
v_mul_f32 v16, s58, v16
v_cvt_pk_bf16_f32 v27, v15, v16
v_cvt_pk_bf16_f32 v15, 0, v15
v_cvt_pk_bf16_f32 v16, 0, v16
v_max3_f32 v14, v14, v15, v16
s_waitcnt vmcnt(7)
s_cbranch_vccnz L_bo_63
s_waitcnt vmcnt(5)
s_cmp_eq_u32 s14, 3
s_cbranch_scc1 L_bo_63
s_waitcnt vmcnt(4)
L_bo_63:
buffer_load_dwordx4 v[120:123], v2, s[40:43], s65 offen offset:2048 nt
s_waitcnt vmcnt(7)
s_cbranch_vccnz L_bo_64
s_waitcnt vmcnt(5)
s_cmp_eq_u32 s14, 3
s_cbranch_scc1 L_bo_64
s_waitcnt vmcnt(4)
L_bo_64:
buffer_load_dwordx4 v[124:127], v2, s[40:43], s65 offen offset:3072 nt
v_mov_b32 v30, 15
ds_write_b32 v3, v30 offset:28416
v_mfma_f32_16x16x32_bf16 v[32:35], v[64:67], v[4:7], 0
v_mfma_f32_16x16x32_bf16 v[36:39], v[68:71], v[4:7], 0
v_mfma_f32_16x16x32_bf16 v[40:43], v[72:75], v[4:7], 0
v_mfma_f32_16x16x32_bf16 v[44:47], v[76:79], v[4:7], 0
v_mfma_f32_16x16x32_bf16 v[48:51], v[80:83], v[4:7], 0
v_mfma_f32_16x16x32_bf16 v[52:55], v[84:87], v[4:7], 0
v_mfma_f32_16x16x32_bf16 v[56:59], v[88:91], v[4:7], 0
v_mfma_f32_16x16x32_bf16 v[60:63], v[92:95], v[4:7], 0
s_nop 1
s_add_u32 s65, s10, 1966080
s_waitcnt lgkmcnt(0)
v_cmp_eq_u32 vcc, 1, v236
v_readfirstlane_b32 s14, v236
ds_read_b32 v236, v237 offset:29468
s_waitcnt vmcnt(7)
s_cbranch_vccnz L_bo_65
s_waitcnt vmcnt(5)
s_cmp_eq_u32 s14, 3
s_cbranch_scc1 L_bo_65
s_waitcnt vmcnt(4)
L_bo_65:
buffer_load_dwordx4 v[128:131], v2, s[40:43], s65 offen offset:0 nt
v_add_f32_dpp v18, v33, v32 row_ror:12 row_mask:0xf bank_mask:0x1
v_add_f32_dpp v19, v37, v36 row_ror:12 row_mask:0xf bank_mask:0x1
s_nop 0
v_add_f32_dpp v18, v34, v18 row_ror:8 row_mask:0xf bank_mask:0x1
v_add_f32_dpp v19, v38, v19 row_ror:8 row_mask:0xf bank_mask:0x1
s_nop 0
v_add_f32_dpp v18, v35, v18 row_ror:4 row_mask:0xf bank_mask:0x1
v_add_f32_dpp v19, v39, v19 row_ror:4 row_mask:0xf bank_mask:0x1
s_nop 0
s_waitcnt vmcnt(7)
s_cbranch_vccnz L_bo_66
s_waitcnt vmcnt(5)
s_cmp_eq_u32 s14, 3
s_cbranch_scc1 L_bo_66
s_waitcnt vmcnt(4)
L_bo_66:
buffer_load_dwordx4 v[132:135], v2, s[40:43], s65 offen offset:1024 nt
s_waitcnt vmcnt(7)
s_cbranch_vccnz L_bo_67
s_waitcnt vmcnt(5)
s_cmp_eq_u32 s14, 3
s_cbranch_scc1 L_bo_67
s_waitcnt vmcnt(4)
L_bo_67:
buffer_load_dwordx4 v[136:139], v2, s[40:43], s65 offen offset:2048 nt
v_add_f32_dpp v18, v42, v41 row_ror:12 row_mask:0xf bank_mask:0x2
v_add_f32_dpp v19, v46, v45 row_ror:12 row_mask:0xf bank_mask:0x2
s_nop 0
v_add_f32_dpp v18, v43, v18 row_ror:8 row_mask:0xf bank_mask:0x2
v_add_f32_dpp v19, v47, v19 row_ror:8 row_mask:0xf bank_mask:0x2
s_nop 0
v_add_f32_dpp v18, v40, v18 row_ror:4 row_mask:0xf bank_mask:0x2
v_add_f32_dpp v19, v44, v19 row_ror:4 row_mask:0xf bank_mask:0x2
s_nop 0
s_waitcnt vmcnt(7)
s_cbranch_vccnz L_bo_68
s_waitcnt vmcnt(5)
s_cmp_eq_u32 s14, 3
s_cbranch_scc1 L_bo_68
s_waitcnt vmcnt(4)
L_bo_68:
buffer_load_dwordx4 v[140:143], v2, s[40:43], s65 offen offset:3072 nt
v_add_f32_dpp v18, v51, v50 row_ror:12 row_mask:0xf bank_mask:0x4
v_add_f32_dpp v19, v55, v54 row_ror:12 row_mask:0xf bank_mask:0x4
s_nop 0
v_add_f32_dpp v18, v48, v18 row_ror:8 row_mask:0xf bank_mask:0x4
v_add_f32_dpp v19, v52, v19 row_ror:8 row_mask:0xf bank_mask:0x4
s_nop 0
v_add_f32_dpp v18, v49, v18 row_ror:4 row_mask:0xf bank_mask:0x4
v_add_f32_dpp v19, v53, v19 row_ror:4 row_mask:0xf bank_mask:0x4
s_nop 0
s_add_u32 s65, s11, 2031616
s_waitcnt lgkmcnt(0)
v_cmp_eq_u32 vcc, 1, v236
v_readfirstlane_b32 s14, v236
ds_read_b32 v236, v237 offset:29468
s_waitcnt vmcnt(7)
s_cbranch_vccnz L_bo_69
s_waitcnt vmcnt(5)
s_cmp_eq_u32 s14, 3
s_cbranch_scc1 L_bo_69
s_waitcnt vmcnt(4)
L_bo_69:
buffer_load_dwordx4 v[144:147], v2, s[40:43], s65 offen offset:0 nt
s_waitcnt vmcnt(7)
s_cbranch_vccnz L_bo_70
s_waitcnt vmcnt(5)
s_cmp_eq_u32 s14, 3
s_cbranch_scc1 L_bo_70
s_waitcnt vmcnt(4)
L_bo_70:
buffer_load_dwordx4 v[148:151], v2, s[40:43], s65 offen offset:1024 nt
v_add_f32_dpp v18, v56, v59 row_ror:12 row_mask:0xf bank_mask:0x8
v_add_f32_dpp v19, v60, v63 row_ror:12 row_mask:0xf bank_mask:0x8
s_nop 0
v_add_f32_dpp v18, v57, v18 row_ror:8 row_mask:0xf bank_mask:0x8
v_add_f32_dpp v19, v61, v19 row_ror:8 row_mask:0xf bank_mask:0x8
s_nop 0
v_add_f32_dpp v18, v58, v18 row_ror:4 row_mask:0xf bank_mask:0x8
v_add_f32_dpp v19, v62, v19 row_ror:4 row_mask:0xf bank_mask:0x8
s_nop 0
v_cvt_pk_bf16_f32 v15, 0, v18
v_cvt_pk_bf16_f32 v16, 0, v19
v_mul_f32 v15, s58, v15
v_mul_f32 v16, s58, v16
v_cvt_pk_bf16_f32 v28, v15, v16
v_cvt_pk_bf16_f32 v15, 0, v15
v_cvt_pk_bf16_f32 v16, 0, v16
v_max3_f32 v14, v14, v15, v16
s_waitcnt vmcnt(7)
s_cbranch_vccnz L_bo_71
s_waitcnt vmcnt(5)
s_cmp_eq_u32 s14, 3
s_cbranch_scc1 L_bo_71
s_waitcnt vmcnt(4)
L_bo_71:
buffer_load_dwordx4 v[152:155], v2, s[40:43], s65 offen offset:2048 nt
s_waitcnt vmcnt(7)
s_cbranch_vccnz L_bo_72
s_waitcnt vmcnt(5)
s_cmp_eq_u32 s14, 3
s_cbranch_scc1 L_bo_72
s_waitcnt vmcnt(4)
L_bo_72:
buffer_load_dwordx4 v[156:159], v2, s[40:43], s65 offen offset:3072 nt
v_mov_b32 v30, 16
ds_write_b32 v3, v30 offset:28416
v_mfma_f32_16x16x32_bf16 v[32:35], v[96:99], v[4:7], 0
v_mfma_f32_16x16x32_bf16 v[36:39], v[100:103], v[4:7], 0
v_mfma_f32_16x16x32_bf16 v[40:43], v[104:107], v[4:7], 0
v_mfma_f32_16x16x32_bf16 v[44:47], v[108:111], v[4:7], 0
v_mfma_f32_16x16x32_bf16 v[48:51], v[112:115], v[4:7], 0
v_mfma_f32_16x16x32_bf16 v[52:55], v[116:119], v[4:7], 0
v_mfma_f32_16x16x32_bf16 v[56:59], v[120:123], v[4:7], 0
v_mfma_f32_16x16x32_bf16 v[60:63], v[124:127], v[4:7], 0
s_nop 1
s_add_u32 s65, s8, 0
s_waitcnt lgkmcnt(0)
v_cmp_eq_u32 vcc, 1, v236
v_readfirstlane_b32 s14, v236
ds_read_b32 v236, v237 offset:29468
s_waitcnt vmcnt(7)
s_cbranch_vccnz L_bo_73
s_waitcnt vmcnt(5)
s_cmp_eq_u32 s14, 3
s_cbranch_scc1 L_bo_73
s_waitcnt vmcnt(4)
L_bo_73:
buffer_load_dwordx4 v[64:67], v1, s[44:47], s65 offen offset:0 nt
v_add_f32_dpp v18, v33, v32 row_ror:12 row_mask:0xf bank_mask:0x1
v_add_f32_dpp v19, v37, v36 row_ror:12 row_mask:0xf bank_mask:0x1
s_nop 0
v_add_f32_dpp v18, v34, v18 row_ror:8 row_mask:0xf bank_mask:0x1
v_add_f32_dpp v19, v38, v19 row_ror:8 row_mask:0xf bank_mask:0x1
s_nop 0
v_add_f32_dpp v18, v35, v18 row_ror:4 row_mask:0xf bank_mask:0x1
v_add_f32_dpp v19, v39, v19 row_ror:4 row_mask:0xf bank_mask:0x1
s_nop 0
s_waitcnt vmcnt(7)
s_cbranch_vccnz L_bo_74
s_waitcnt vmcnt(5)
s_cmp_eq_u32 s14, 3
s_cbranch_scc1 L_bo_74
s_waitcnt vmcnt(4)
L_bo_74:
buffer_load_dwordx4 v[68:71], v1, s[44:47], s65 offen offset:1024 nt
s_waitcnt vmcnt(7)
s_cbranch_vccnz L_bo_75
s_waitcnt vmcnt(5)
s_cmp_eq_u32 s14, 3
s_cbranch_scc1 L_bo_75
s_waitcnt vmcnt(4)
L_bo_75:
buffer_load_dwordx4 v[72:75], v1, s[44:47], s65 offen offset:2048 nt
v_add_f32_dpp v18, v42, v41 row_ror:12 row_mask:0xf bank_mask:0x2
v_add_f32_dpp v19, v46, v45 row_ror:12 row_mask:0xf bank_mask:0x2
s_nop 0
v_add_f32_dpp v18, v43, v18 row_ror:8 row_mask:0xf bank_mask:0x2
v_add_f32_dpp v19, v47, v19 row_ror:8 row_mask:0xf bank_mask:0x2
s_nop 0
v_add_f32_dpp v18, v40, v18 row_ror:4 row_mask:0xf bank_mask:0x2
v_add_f32_dpp v19, v44, v19 row_ror:4 row_mask:0xf bank_mask:0x2
s_nop 0
s_waitcnt vmcnt(7)
s_cbranch_vccnz L_bo_76
s_waitcnt vmcnt(5)
s_cmp_eq_u32 s14, 3
s_cbranch_scc1 L_bo_76
s_waitcnt vmcnt(4)
L_bo_76:
buffer_load_dwordx4 v[76:79], v1, s[44:47], s65 offen offset:3072 nt
v_add_f32_dpp v18, v51, v50 row_ror:12 row_mask:0xf bank_mask:0x4
v_add_f32_dpp v19, v55, v54 row_ror:12 row_mask:0xf bank_mask:0x4
s_nop 0
v_add_f32_dpp v18, v48, v18 row_ror:8 row_mask:0xf bank_mask:0x4
v_add_f32_dpp v19, v52, v19 row_ror:8 row_mask:0xf bank_mask:0x4
s_nop 0
v_add_f32_dpp v18, v49, v18 row_ror:4 row_mask:0xf bank_mask:0x4
v_add_f32_dpp v19, v53, v19 row_ror:4 row_mask:0xf bank_mask:0x4
s_nop 0
s_add_u32 s65, s9, 65536
s_waitcnt lgkmcnt(0)
v_cmp_eq_u32 vcc, 1, v236
v_readfirstlane_b32 s14, v236
ds_read_b32 v236, v237 offset:29468
s_waitcnt vmcnt(7)
s_cbranch_vccnz L_bo_77
s_waitcnt vmcnt(5)
s_cmp_eq_u32 s14, 3
s_cbranch_scc1 L_bo_77
s_waitcnt vmcnt(4)
L_bo_77:
buffer_load_dwordx4 v[80:83], v1, s[44:47], s65 offen offset:0 nt
s_waitcnt vmcnt(7)
s_cbranch_vccnz L_bo_78
s_waitcnt vmcnt(5)
s_cmp_eq_u32 s14, 3
s_cbranch_scc1 L_bo_78
s_waitcnt vmcnt(4)
L_bo_78:
buffer_load_dwordx4 v[84:87], v1, s[44:47], s65 offen offset:1024 nt
v_add_f32_dpp v18, v56, v59 row_ror:12 row_mask:0xf bank_mask:0x8
v_add_f32_dpp v19, v60, v63 row_ror:12 row_mask:0xf bank_mask:0x8
s_nop 0
v_add_f32_dpp v18, v57, v18 row_ror:8 row_mask:0xf bank_mask:0x8
v_add_f32_dpp v19, v61, v19 row_ror:8 row_mask:0xf bank_mask:0x8
s_nop 0
v_add_f32_dpp v18, v58, v18 row_ror:4 row_mask:0xf bank_mask:0x8
v_add_f32_dpp v19, v62, v19 row_ror:4 row_mask:0xf bank_mask:0x8
s_nop 0
v_cvt_pk_bf16_f32 v15, 0, v18
v_cvt_pk_bf16_f32 v16, 0, v19
v_mul_f32 v15, s58, v15
v_mul_f32 v16, s58, v16
v_cvt_pk_bf16_f32 v29, v15, v16
v_cvt_pk_bf16_f32 v15, 0, v15
v_cvt_pk_bf16_f32 v16, 0, v16
v_max3_f32 v14, v14, v15, v16
s_waitcnt vmcnt(7)
s_cbranch_vccnz L_bo_79
s_waitcnt vmcnt(5)
s_cmp_eq_u32 s14, 3
s_cbranch_scc1 L_bo_79
s_waitcnt vmcnt(4)
L_bo_79:
buffer_load_dwordx4 v[88:91], v1, s[44:47], s65 offen offset:2048 nt
s_waitcnt vmcnt(7)
s_cbranch_vccnz L_bo_80
s_waitcnt vmcnt(5)
s_cmp_eq_u32 s14, 3
s_cbranch_scc1 L_bo_80
s_waitcnt vmcnt(4)
L_bo_80:
buffer_load_dwordx4 v[92:95], v1, s[44:47], s65 offen offset:3072 nt
v_mov_b32 v30, 17
ds_write_b32 v3, v30 offset:28416
v_mfma_f32_16x16x32_bf16 v[32:35], v[128:131], v[4:7], 0
v_mfma_f32_16x16x32_bf16 v[36:39], v[132:135], v[4:7], 0
v_mfma_f32_16x16x32_bf16 v[40:43], v[136:139], v[4:7], 0
v_mfma_f32_16x16x32_bf16 v[44:47], v[140:143], v[4:7], 0
v_mfma_f32_16x16x32_bf16 v[48:51], v[144:147], v[4:7], 0
v_mfma_f32_16x16x32_bf16 v[52:55], v[148:151], v[4:7], 0
v_mfma_f32_16x16x32_bf16 v[56:59], v[152:155], v[4:7], 0
v_mfma_f32_16x16x32_bf16 v[60:63], v[156:159], v[4:7], 0
s_nop 1
s_add_u32 s65, s10, 131072
s_waitcnt lgkmcnt(0)
v_cmp_eq_u32 vcc, 1, v236
v_readfirstlane_b32 s14, v236
ds_read_b32 v236, v237 offset:29468
s_waitcnt vmcnt(7)
s_cbranch_vccnz L_bo_81
s_waitcnt vmcnt(5)
s_cmp_eq_u32 s14, 3
s_cbranch_scc1 L_bo_81
s_waitcnt vmcnt(4)
L_bo_81:
buffer_load_dwordx4 v[96:99], v1, s[44:47], s65 offen offset:0 nt
v_add_f32_dpp v18, v33, v32 row_ror:12 row_mask:0xf bank_mask:0x1
v_add_f32_dpp v19, v37, v36 row_ror:12 row_mask:0xf bank_mask:0x1
s_nop 0
v_add_f32_dpp v18, v34, v18 row_ror:8 row_mask:0xf bank_mask:0x1
v_add_f32_dpp v19, v38, v19 row_ror:8 row_mask:0xf bank_mask:0x1
s_nop 0
v_add_f32_dpp v18, v35, v18 row_ror:4 row_mask:0xf bank_mask:0x1
v_add_f32_dpp v19, v39, v19 row_ror:4 row_mask:0xf bank_mask:0x1
s_nop 0
s_waitcnt vmcnt(7)
s_cbranch_vccnz L_bo_82
s_waitcnt vmcnt(5)
s_cmp_eq_u32 s14, 3
s_cbranch_scc1 L_bo_82
s_waitcnt vmcnt(4)
L_bo_82:
buffer_load_dwordx4 v[100:103], v1, s[44:47], s65 offen offset:1024 nt
s_waitcnt vmcnt(7)
s_cbranch_vccnz L_bo_83
s_waitcnt vmcnt(5)
s_cmp_eq_u32 s14, 3
s_cbranch_scc1 L_bo_83
s_waitcnt vmcnt(4)
L_bo_83:
buffer_load_dwordx4 v[104:107], v1, s[44:47], s65 offen offset:2048 nt
v_add_f32_dpp v18, v42, v41 row_ror:12 row_mask:0xf bank_mask:0x2
v_add_f32_dpp v19, v46, v45 row_ror:12 row_mask:0xf bank_mask:0x2
s_nop 0
v_add_f32_dpp v18, v43, v18 row_ror:8 row_mask:0xf bank_mask:0x2
v_add_f32_dpp v19, v47, v19 row_ror:8 row_mask:0xf bank_mask:0x2
s_nop 0
v_add_f32_dpp v18, v40, v18 row_ror:4 row_mask:0xf bank_mask:0x2
v_add_f32_dpp v19, v44, v19 row_ror:4 row_mask:0xf bank_mask:0x2
s_nop 0
s_waitcnt vmcnt(7)
s_cbranch_vccnz L_bo_84
s_waitcnt vmcnt(5)
s_cmp_eq_u32 s14, 3
s_cbranch_scc1 L_bo_84
s_waitcnt vmcnt(4)
L_bo_84:
buffer_load_dwordx4 v[108:111], v1, s[44:47], s65 offen offset:3072 nt
v_add_f32_dpp v18, v51, v50 row_ror:12 row_mask:0xf bank_mask:0x4
v_add_f32_dpp v19, v55, v54 row_ror:12 row_mask:0xf bank_mask:0x4
s_nop 0
v_add_f32_dpp v18, v48, v18 row_ror:8 row_mask:0xf bank_mask:0x4
v_add_f32_dpp v19, v52, v19 row_ror:8 row_mask:0xf bank_mask:0x4
s_nop 0
v_add_f32_dpp v18, v49, v18 row_ror:4 row_mask:0xf bank_mask:0x4
v_add_f32_dpp v19, v53, v19 row_ror:4 row_mask:0xf bank_mask:0x4
s_nop 0
s_add_u32 s65, s11, 196608
s_waitcnt lgkmcnt(0)
v_cmp_eq_u32 vcc, 1, v236
v_readfirstlane_b32 s14, v236
ds_read_b32 v236, v237 offset:29468
s_waitcnt vmcnt(7)
s_cbranch_vccnz L_bo_85
s_waitcnt vmcnt(5)
s_cmp_eq_u32 s14, 3
s_cbranch_scc1 L_bo_85
s_waitcnt vmcnt(4)
L_bo_85:
buffer_load_dwordx4 v[112:115], v1, s[44:47], s65 offen offset:0 nt
s_waitcnt vmcnt(7)
s_cbranch_vccnz L_bo_86
s_waitcnt vmcnt(5)
s_cmp_eq_u32 s14, 3
s_cbranch_scc1 L_bo_86
s_waitcnt vmcnt(4)
L_bo_86:
buffer_load_dwordx4 v[116:119], v1, s[44:47], s65 offen offset:1024 nt
v_add_f32_dpp v18, v56, v59 row_ror:12 row_mask:0xf bank_mask:0x8
v_add_f32_dpp v19, v60, v63 row_ror:12 row_mask:0xf bank_mask:0x8
s_nop 0
v_add_f32_dpp v18, v57, v18 row_ror:8 row_mask:0xf bank_mask:0x8
v_add_f32_dpp v19, v61, v19 row_ror:8 row_mask:0xf bank_mask:0x8
s_nop 0
v_add_f32_dpp v18, v58, v18 row_ror:4 row_mask:0xf bank_mask:0x8
v_add_f32_dpp v19, v62, v19 row_ror:4 row_mask:0xf bank_mask:0x8
s_nop 0
v_cvt_pk_bf16_f32 v15, 0, v18
v_cvt_pk_bf16_f32 v16, 0, v19
v_mul_f32 v15, s58, v15
v_mul_f32 v16, s58, v16
v_cvt_pk_bf16_f32 v238, v15, v16
v_cvt_pk_bf16_f32 v15, 0, v15
v_cvt_pk_bf16_f32 v16, 0, v16
v_max3_f32 v14, v14, v15, v16
s_waitcnt vmcnt(7)
s_cbranch_vccnz L_bo_87
s_waitcnt vmcnt(5)
s_cmp_eq_u32 s14, 3
s_cbranch_scc1 L_bo_87
s_waitcnt vmcnt(4)
L_bo_87:
buffer_load_dwordx4 v[120:123], v1, s[44:47], s65 offen offset:2048 nt
s_waitcnt vmcnt(7)
s_cbranch_vccnz L_bo_88
s_waitcnt vmcnt(5)
s_cmp_eq_u32 s14, 3
s_cbranch_scc1 L_bo_88
s_waitcnt vmcnt(4)
L_bo_88:
buffer_load_dwordx4 v[124:127], v1, s[44:47], s65 offen offset:3072 nt
v_mov_b32 v30, 18
ds_write_b32 v3, v30 offset:28416
s_nop 1
v_max_f32_dpp v14, v14, v14 row_ror:4 row_mask:0xf bank_mask:0xf
s_nop 1
v_max_f32_dpp v14, v14, v14 row_ror:8 row_mask:0xf bank_mask:0xf
v_mov_b32 v31, v14
s_nop 1
v_permlane16_swap_b32 v14, v31
v_max_f32 v14, v14, v31
v_mov_b32 v31, v14
s_nop 1
v_permlane32_swap_b32 v14, v31
v_max_f32 v14, v14, v31
v_mul_f32 v17, s59, v14
v_mov_b32 v24, 0
v_lshlrev_b32 v18, 16, v8
v_and_b32 v19, s60, v8
v_sub_f32 v18, v18, v14
v_sub_f32 v19, v19, v14
v_mul_f32 v18, s59, v18
v_mul_f32 v19, s59, v19
v_exp_f32 v18, v18
v_exp_f32 v19, v19
s_nop 0
v_cvt_pk_bf16_f32 v8, v18, v19
v_add_f32 v24, v24, v18
v_add_f32 v24, v24, v19
v_lshlrev_b32 v18, 16, v9
v_and_b32 v19, s60, v9
v_sub_f32 v18, v18, v14
v_sub_f32 v19, v19, v14
v_mul_f32 v18, s59, v18
v_mul_f32 v19, s59, v19
v_exp_f32 v18, v18
v_exp_f32 v19, v19
s_nop 0
v_cvt_pk_bf16_f32 v9, v18, v19
v_add_f32 v24, v24, v18
v_add_f32 v24, v24, v19
v_lshlrev_b32 v18, 16, v10
v_and_b32 v19, s60, v10
v_sub_f32 v18, v18, v14
v_sub_f32 v19, v19, v14
v_mul_f32 v18, s59, v18
v_mul_f32 v19, s59, v19
v_exp_f32 v18, v18
v_exp_f32 v19, v19
s_nop 0
v_cvt_pk_bf16_f32 v10, v18, v19
v_add_f32 v24, v24, v18
v_add_f32 v24, v24, v19
s_add_u32 s65, s8, 262144
s_waitcnt lgkmcnt(0)
v_cmp_eq_u32 vcc, 1, v236
v_readfirstlane_b32 s14, v236
ds_read_b32 v236, v237 offset:29468
s_waitcnt vmcnt(7)
s_cbranch_vccnz L_bo_89
s_waitcnt vmcnt(5)
s_cmp_eq_u32 s14, 3
s_cbranch_scc1 L_bo_89
s_waitcnt vmcnt(4)
L_bo_89:
buffer_load_dwordx4 v[128:131], v1, s[44:47], s65 offen offset:0 nt
v_lshlrev_b32 v18, 16, v11
v_and_b32 v19, s60, v11
v_sub_f32 v18, v18, v14
v_sub_f32 v19, v19, v14
v_mul_f32 v18, s59, v18
v_mul_f32 v19, s59, v19
v_exp_f32 v18, v18
v_exp_f32 v19, v19
s_nop 0
v_cvt_pk_bf16_f32 v11, v18, v19
v_add_f32 v24, v24, v18
v_add_f32 v24, v24, v19
v_lshlrev_b32 v18, 16, v12
v_and_b32 v19, s60, v12
v_sub_f32 v18, v18, v14
v_sub_f32 v19, v19, v14
v_mul_f32 v18, s59, v18
v_mul_f32 v19, s59, v19
v_exp_f32 v18, v18
v_exp_f32 v19, v19
s_nop 0
v_cvt_pk_bf16_f32 v12, v18, v19
v_add_f32 v24, v24, v18
v_add_f32 v24, v24, v19
v_lshlrev_b32 v18, 16, v13
v_and_b32 v19, s60, v13
v_sub_f32 v18, v18, v14
v_sub_f32 v19, v19, v14
v_mul_f32 v18, s59, v18
v_mul_f32 v19, s59, v19
v_exp_f32 v18, v18
v_exp_f32 v19, v19
s_nop 0
v_cvt_pk_bf16_f32 v13, v18, v19
v_add_f32 v24, v24, v18
v_add_f32 v24, v24, v19
s_waitcnt vmcnt(7)
s_cbranch_vccnz L_bo_90
s_waitcnt vmcnt(5)
s_cmp_eq_u32 s14, 3
s_cbranch_scc1 L_bo_90
s_waitcnt vmcnt(4)
L_bo_90:
buffer_load_dwordx4 v[132:135], v1, s[44:47], s65 offen offset:1024 nt
v_lshlrev_b32 v18, 16, v20
v_and_b32 v19, s60, v20
v_sub_f32 v18, v18, v14
v_sub_f32 v19, v19, v14
v_mul_f32 v18, s59, v18
v_mul_f32 v19, s59, v19
v_exp_f32 v18, v18
v_exp_f32 v19, v19
s_nop 0
v_cvt_pk_bf16_f32 v20, v18, v19
v_add_f32 v24, v24, v18
v_add_f32 v24, v24, v19
v_lshlrev_b32 v18, 16, v21
v_and_b32 v19, s60, v21
v_sub_f32 v18, v18, v14
v_sub_f32 v19, v19, v14
v_mul_f32 v18, s59, v18
v_mul_f32 v19, s59, v19
v_exp_f32 v18, v18
v_exp_f32 v19, v19
s_nop 0
v_cvt_pk_bf16_f32 v21, v18, v19
v_add_f32 v24, v24, v18
v_add_f32 v24, v24, v19
v_lshlrev_b32 v18, 16, v22
v_and_b32 v19, s60, v22
v_sub_f32 v18, v18, v14
v_sub_f32 v19, v19, v14
v_mul_f32 v18, s59, v18
v_mul_f32 v19, s59, v19
v_exp_f32 v18, v18
v_exp_f32 v19, v19
s_nop 0
v_cvt_pk_bf16_f32 v22, v18, v19
v_add_f32 v24, v24, v18
v_add_f32 v24, v24, v19
v_lshlrev_b32 v18, 16, v23
v_and_b32 v19, s60, v23
v_sub_f32 v18, v18, v14
v_sub_f32 v19, v19, v14
v_mul_f32 v18, s59, v18
v_mul_f32 v19, s59, v19
v_exp_f32 v18, v18
v_exp_f32 v19, v19
s_nop 0
v_cvt_pk_bf16_f32 v23, v18, v19
v_add_f32 v24, v24, v18
v_add_f32 v24, v24, v19
s_waitcnt vmcnt(7)
s_cbranch_vccnz L_bo_91
s_waitcnt vmcnt(5)
s_cmp_eq_u32 s14, 3
s_cbranch_scc1 L_bo_91
s_waitcnt vmcnt(4)
L_bo_91:
buffer_load_dwordx4 v[136:139], v1, s[44:47], s65 offen offset:2048 nt
v_lshlrev_b32 v18, 16, v25
v_and_b32 v19, s60, v25
v_sub_f32 v18, v18, v14
v_sub_f32 v19, v19, v14
v_mul_f32 v18, s59, v18
v_mul_f32 v19, s59, v19
v_exp_f32 v18, v18
v_exp_f32 v19, v19
s_nop 0
v_cvt_pk_bf16_f32 v25, v18, v19
v_add_f32 v24, v24, v18
v_add_f32 v24, v24, v19
v_lshlrev_b32 v18, 16, v26
v_and_b32 v19, s60, v26
v_sub_f32 v18, v18, v14
v_sub_f32 v19, v19, v14
v_mul_f32 v18, s59, v18
v_mul_f32 v19, s59, v19
v_exp_f32 v18, v18
v_exp_f32 v19, v19
s_nop 0
v_cvt_pk_bf16_f32 v26, v18, v19
v_add_f32 v24, v24, v18
v_add_f32 v24, v24, v19
v_lshlrev_b32 v18, 16, v27
v_and_b32 v19, s60, v27
v_sub_f32 v18, v18, v14
v_sub_f32 v19, v19, v14
v_mul_f32 v18, s59, v18
v_mul_f32 v19, s59, v19
v_exp_f32 v18, v18
v_exp_f32 v19, v19
s_nop 0
v_cvt_pk_bf16_f32 v27, v18, v19
v_add_f32 v24, v24, v18
v_add_f32 v24, v24, v19
s_waitcnt vmcnt(7)
s_cbranch_vccnz L_bo_92
s_waitcnt vmcnt(5)
s_cmp_eq_u32 s14, 3
s_cbranch_scc1 L_bo_92
s_waitcnt vmcnt(4)
L_bo_92:
buffer_load_dwordx4 v[140:143], v1, s[44:47], s65 offen offset:3072 nt
v_lshlrev_b32 v18, 16, v28
v_and_b32 v19, s60, v28
v_sub_f32 v18, v18, v14
v_sub_f32 v19, v19, v14
v_mul_f32 v18, s59, v18
v_mul_f32 v19, s59, v19
v_exp_f32 v18, v18
v_exp_f32 v19, v19
s_nop 0
v_cvt_pk_bf16_f32 v28, v18, v19
v_add_f32 v24, v24, v18
v_add_f32 v24, v24, v19
v_lshlrev_b32 v18, 16, v29
v_and_b32 v19, s60, v29
v_sub_f32 v18, v18, v14
v_sub_f32 v19, v19, v14
v_mul_f32 v18, s59, v18
v_mul_f32 v19, s59, v19
v_exp_f32 v18, v18
v_exp_f32 v19, v19
s_nop 0
v_cvt_pk_bf16_f32 v29, v18, v19
v_add_f32 v24, v24, v18
v_add_f32 v24, v24, v19
v_lshlrev_b32 v18, 16, v238
v_and_b32 v19, s60, v238
v_sub_f32 v18, v18, v14
v_sub_f32 v19, v19, v14
v_mul_f32 v18, s59, v18
v_mul_f32 v19, s59, v19
v_exp_f32 v18, v18
v_exp_f32 v19, v19
s_nop 0
v_cvt_pk_bf16_f32 v238, v18, v19
v_add_f32 v24, v24, v18
v_add_f32 v24, v24, v19
s_nop 1
v_add_f32_dpp v24, v24, v24 row_ror:4 row_mask:0xf bank_mask:0xf
s_nop 1
v_add_f32_dpp v24, v24, v24 row_ror:8 row_mask:0xf bank_mask:0xf
v_mov_b32 v31, v24
s_nop 1
v_permlane16_swap_b32 v24, v31
v_add_f32 v24, v24, v31
v_mov_b32 v31, v24
s_nop 1
v_permlane32_swap_b32 v24, v31
v_add_f32 v24, v24, v31
s_add_u32 s65, s9, 327680
s_waitcnt lgkmcnt(0)
v_cmp_eq_u32 vcc, 1, v236
v_readfirstlane_b32 s14, v236
ds_read_b32 v236, v237 offset:29468
s_waitcnt vmcnt(7)
s_cbranch_vccnz L_bo_93
s_waitcnt vmcnt(5)
s_cmp_eq_u32 s14, 3
s_cbranch_scc1 L_bo_93
s_waitcnt vmcnt(4)
L_bo_93:
buffer_load_dwordx4 v[144:147], v1, s[44:47], s65 offen offset:0 nt
s_lshl_b32 s55, s52, 2
v_and_b32 v31, 0x30, v1
v_lshl_add_u32 v31, v31, 1, s55
v_mov_b32 v18, 0
v_mov_b32 v19, 1
s_mov_b64 exec, 0xf
ds_write2_b32 v31, v17, v24 offset0:16 offset1:20
s_mov_b64 exec, 1
s_waitcnt lgkmcnt(0)
ds_add_u32 v18, v19 offset:29476
s_mov_b64 exec, -1
v_mov_b32 v224, v8
v_mov_b32_dpp v225, v8 row_ror:12 row_mask:0xf bank_mask:0xf
v_mov_b32_dpp v226, v8 row_ror:8 row_mask:0xf bank_mask:0xf
v_mov_b32_dpp v227, v8 row_ror:4 row_mask:0xf bank_mask:0xf
v_perm_b32 v228, v68, v64, s56
v_perm_b32 v229, v76, v72, s56
v_perm_b32 v230, v84, v80, s56
v_perm_b32 v231, v92, v88, s56
v_perm_b32 v232, v68, v64, s57
v_perm_b32 v233, v76, v72, s57
v_perm_b32 v234, v84, v80, s57
v_perm_b32 v235, v92, v88, s57
v_mfma_f32_16x16x32_bf16 v[32:35], v[228:231], v[224:227], 0
s_waitcnt vmcnt(7)
s_cbranch_vccnz L_bo_94
s_waitcnt vmcnt(5)
s_cmp_eq_u32 s14, 3
s_cbranch_scc1 L_bo_94
s_waitcnt vmcnt(4)
L_bo_94:
buffer_load_dwordx4 v[148:151], v1, s[44:47], s65 offen offset:1024 nt
v_perm_b32 v228, v69, v65, s56
v_perm_b32 v229, v77, v73, s56
v_perm_b32 v230, v85, v81, s56
v_perm_b32 v231, v93, v89, s56
v_mfma_f32_16x16x32_bf16 v[36:39], v[232:235], v[224:227], 0
v_perm_b32 v232, v69, v65, s57
v_perm_b32 v233, v77, v73, s57
v_perm_b32 v234, v85, v81, s57
v_perm_b32 v235, v93, v89, s57
v_mfma_f32_16x16x32_bf16 v[40:43], v[228:231], v[224:227], 0
v_perm_b32 v228, v70, v66, s56
v_perm_b32 v229, v78, v74, s56
v_perm_b32 v230, v86, v82, s56
v_perm_b32 v231, v94, v90, s56
v_mfma_f32_16x16x32_bf16 v[44:47], v[232:235], v[224:227], 0
v_perm_b32 v232, v70, v66, s57
v_perm_b32 v233, v78, v74, s57
v_perm_b32 v234, v86, v82, s57
v_perm_b32 v235, v94, v90, s57
v_mfma_f32_16x16x32_bf16 v[48:51], v[228:231], v[224:227], 0
s_waitcnt vmcnt(7)
s_cbranch_vccnz L_bo_95
s_waitcnt vmcnt(5)
s_cmp_eq_u32 s14, 3
s_cbranch_scc1 L_bo_95
s_waitcnt vmcnt(4)
L_bo_95:
buffer_load_dwordx4 v[152:155], v1, s[44:47], s65 offen offset:2048 nt
v_perm_b32 v228, v71, v67, s56
v_perm_b32 v229, v79, v75, s56
v_perm_b32 v230, v87, v83, s56
v_perm_b32 v231, v95, v91, s56
v_mfma_f32_16x16x32_bf16 v[52:55], v[232:235], v[224:227], 0
v_perm_b32 v232, v71, v67, s57
v_perm_b32 v233, v79, v75, s57
v_perm_b32 v234, v87, v83, s57
v_perm_b32 v235, v95, v91, s57
v_mfma_f32_16x16x32_bf16 v[56:59], v[228:231], v[224:227], 0
s_nop 1
v_mfma_f32_16x16x32_bf16 v[60:63], v[232:235], v[224:227], 0
s_waitcnt vmcnt(7)
s_cbranch_vccnz L_bo_96
s_waitcnt vmcnt(5)
s_cmp_eq_u32 s14, 3
s_cbranch_scc1 L_bo_96
s_waitcnt vmcnt(4)
L_bo_96:
buffer_load_dwordx4 v[156:159], v1, s[44:47], s65 offen offset:3072 nt
v_mov_b32 v30, 19
ds_write_b32 v3, v30 offset:28416
v_mov_b32 v224, v9
v_mov_b32_dpp v225, v9 row_ror:12 row_mask:0xf bank_mask:0xf
v_mov_b32_dpp v226, v9 row_ror:8 row_mask:0xf bank_mask:0xf
v_mov_b32_dpp v227, v9 row_ror:4 row_mask:0xf bank_mask:0xf
v_perm_b32 v228, v100, v96, s56
v_perm_b32 v229, v108, v104, s56
v_perm_b32 v230, v116, v112, s56
v_perm_b32 v231, v124, v120, s56
v_perm_b32 v232, v100, v96, s57
v_perm_b32 v233, v108, v104, s57
v_perm_b32 v234, v116, v112, s57
v_perm_b32 v235, v124, v120, s57
v_mfma_f32_16x16x32_bf16 v[32:35], v[228:231], v[224:227], v[32:35]
s_add_u32 s65, s10, 393216
s_waitcnt lgkmcnt(0)
v_cmp_eq_u32 vcc, 1, v236
v_readfirstlane_b32 s14, v236
ds_read_b32 v236, v237 offset:29468
s_waitcnt vmcnt(7)
s_cbranch_vccnz L_bo_97
s_waitcnt vmcnt(5)
s_cmp_eq_u32 s14, 3
s_cbranch_scc1 L_bo_97
s_waitcnt vmcnt(4)
L_bo_97:
buffer_load_dwordx4 v[64:67], v1, s[44:47], s65 offen offset:0 nt
v_perm_b32 v228, v101, v97, s56
v_perm_b32 v229, v109, v105, s56
v_perm_b32 v230, v117, v113, s56
v_perm_b32 v231, v125, v121, s56
v_mfma_f32_16x16x32_bf16 v[36:39], v[232:235], v[224:227], v[36:39]
s_waitcnt vmcnt(7)
s_cbranch_vccnz L_bo_98
s_waitcnt vmcnt(5)
s_cmp_eq_u32 s14, 3
s_cbranch_scc1 L_bo_98
s_waitcnt vmcnt(4)
L_bo_98:
buffer_load_dwordx4 v[68:71], v1, s[44:47], s65 offen offset:1024 nt
v_perm_b32 v232, v101, v97, s57
v_perm_b32 v233, v109, v105, s57
v_perm_b32 v234, v117, v113, s57
v_perm_b32 v235, v125, v121, s57
v_mfma_f32_16x16x32_bf16 v[40:43], v[228:231], v[224:227], v[40:43]
s_waitcnt vmcnt(7)
s_cbranch_vccnz L_bo_99
s_waitcnt vmcnt(5)
s_cmp_eq_u32 s14, 3
s_cbranch_scc1 L_bo_99
s_waitcnt vmcnt(4)
L_bo_99:
buffer_load_dwordx4 v[72:75], v1, s[44:47], s65 offen offset:2048 nt
v_perm_b32 v228, v102, v98, s56
v_perm_b32 v229, v110, v106, s56
v_perm_b32 v230, v118, v114, s56
v_perm_b32 v231, v126, v122, s56
v_mfma_f32_16x16x32_bf16 v[44:47], v[232:235], v[224:227], v[44:47]
s_waitcnt vmcnt(7)
s_cbranch_vccnz L_bo_100
s_waitcnt vmcnt(5)
s_cmp_eq_u32 s14, 3
s_cbranch_scc1 L_bo_100
s_waitcnt vmcnt(4)
L_bo_100:
buffer_load_dwordx4 v[76:79], v1, s[44:47], s65 offen offset:3072 nt
v_perm_b32 v232, v102, v98, s57
v_perm_b32 v233, v110, v106, s57
v_perm_b32 v234, v118, v114, s57
v_perm_b32 v235, v126, v122, s57
v_mfma_f32_16x16x32_bf16 v[48:51], v[228:231], v[224:227], v[48:51]
s_add_u32 s65, s11, 458752
s_waitcnt lgkmcnt(0)
v_cmp_eq_u32 vcc, 1, v236
v_readfirstlane_b32 s14, v236
ds_read_b32 v236, v237 offset:29468
s_waitcnt vmcnt(7)
s_cbranch_vccnz L_bo_101
s_waitcnt vmcnt(5)
s_cmp_eq_u32 s14, 3
s_cbranch_scc1 L_bo_101
s_waitcnt vmcnt(4)
L_bo_101:
buffer_load_dwordx4 v[80:83], v1, s[44:47], s65 offen offset:0 nt
v_perm_b32 v228, v103, v99, s56
v_perm_b32 v229, v111, v107, s56
v_perm_b32 v230, v119, v115, s56
v_perm_b32 v231, v127, v123, s56
v_mfma_f32_16x16x32_bf16 v[52:55], v[232:235], v[224:227], v[52:55]
s_waitcnt vmcnt(7)
s_cbranch_vccnz L_bo_102
s_waitcnt vmcnt(5)
s_cmp_eq_u32 s14, 3
s_cbranch_scc1 L_bo_102
s_waitcnt vmcnt(4)
L_bo_102:
buffer_load_dwordx4 v[84:87], v1, s[44:47], s65 offen offset:1024 nt
v_perm_b32 v232, v103, v99, s57
v_perm_b32 v233, v111, v107, s57
v_perm_b32 v234, v119, v115, s57
v_perm_b32 v235, v127, v123, s57
v_mfma_f32_16x16x32_bf16 v[56:59], v[228:231], v[224:227], v[56:59]
s_waitcnt vmcnt(7)
s_cbranch_vccnz L_bo_103
s_waitcnt vmcnt(5)
s_cmp_eq_u32 s14, 3
s_cbranch_scc1 L_bo_103
s_waitcnt vmcnt(4)
L_bo_103:
buffer_load_dwordx4 v[88:91], v1, s[44:47], s65 offen offset:2048 nt
s_nop 1
v_mfma_f32_16x16x32_bf16 v[60:63], v[232:235], v[224:227], v[60:63]
s_waitcnt vmcnt(7)
s_cbranch_vccnz L_bo_104
s_waitcnt vmcnt(5)
s_cmp_eq_u32 s14, 3
s_cbranch_scc1 L_bo_104
s_waitcnt vmcnt(4)
L_bo_104:
buffer_load_dwordx4 v[92:95], v1, s[44:47], s65 offen offset:3072 nt
v_mov_b32 v30, 20
ds_write_b32 v3, v30 offset:28416
v_mov_b32 v224, v10
v_mov_b32_dpp v225, v10 row_ror:12 row_mask:0xf bank_mask:0xf
v_mov_b32_dpp v226, v10 row_ror:8 row_mask:0xf bank_mask:0xf
v_mov_b32_dpp v227, v10 row_ror:4 row_mask:0xf bank_mask:0xf
v_perm_b32 v228, v132, v128, s56
v_perm_b32 v229, v140, v136, s56
v_perm_b32 v230, v148, v144, s56
v_perm_b32 v231, v156, v152, s56
v_perm_b32 v232, v132, v128, s57
v_perm_b32 v233, v140, v136, s57
v_perm_b32 v234, v148, v144, s57
v_perm_b32 v235, v156, v152, s57
v_mfma_f32_16x16x32_bf16 v[32:35], v[228:231], v[224:227], v[32:35]
s_add_u32 s65, s8, 524288
s_waitcnt lgkmcnt(0)
v_cmp_eq_u32 vcc, 1, v236
v_readfirstlane_b32 s14, v236
ds_read_b32 v236, v237 offset:29468
s_waitcnt vmcnt(7)
s_cbranch_vccnz L_bo_105
s_waitcnt vmcnt(5)
s_cmp_eq_u32 s14, 3
s_cbranch_scc1 L_bo_105
s_waitcnt vmcnt(4)
L_bo_105:
buffer_load_dwordx4 v[96:99], v1, s[44:47], s65 offen offset:0 nt
v_perm_b32 v228, v133, v129, s56
v_perm_b32 v229, v141, v137, s56
v_perm_b32 v230, v149, v145, s56
v_perm_b32 v231, v157, v153, s56
v_mfma_f32_16x16x32_bf16 v[36:39], v[232:235], v[224:227], v[36:39]
s_waitcnt vmcnt(7)
s_cbranch_vccnz L_bo_106
s_waitcnt vmcnt(5)
s_cmp_eq_u32 s14, 3
s_cbranch_scc1 L_bo_106
s_waitcnt vmcnt(4)
L_bo_106:
buffer_load_dwordx4 v[100:103], v1, s[44:47], s65 offen offset:1024 nt
v_perm_b32 v232, v133, v129, s57
v_perm_b32 v233, v141, v137, s57
v_perm_b32 v234, v149, v145, s57
v_perm_b32 v235, v157, v153, s57
v_mfma_f32_16x16x32_bf16 v[40:43], v[228:231], v[224:227], v[40:43]
s_waitcnt vmcnt(7)
s_cbranch_vccnz L_bo_107
s_waitcnt vmcnt(5)
s_cmp_eq_u32 s14, 3
s_cbranch_scc1 L_bo_107
s_waitcnt vmcnt(4)
L_bo_107:
buffer_load_dwordx4 v[104:107], v1, s[44:47], s65 offen offset:2048 nt
v_perm_b32 v228, v134, v130, s56
v_perm_b32 v229, v142, v138, s56
v_perm_b32 v230, v150, v146, s56
v_perm_b32 v231, v158, v154, s56
v_mfma_f32_16x16x32_bf16 v[44:47], v[232:235], v[224:227], v[44:47]
s_waitcnt vmcnt(7)
s_cbranch_vccnz L_bo_108
s_waitcnt vmcnt(5)
s_cmp_eq_u32 s14, 3
s_cbranch_scc1 L_bo_108
s_waitcnt vmcnt(4)
L_bo_108:
buffer_load_dwordx4 v[108:111], v1, s[44:47], s65 offen offset:3072 nt
v_perm_b32 v232, v134, v130, s57
v_perm_b32 v233, v142, v138, s57
v_perm_b32 v234, v150, v146, s57
v_perm_b32 v235, v158, v154, s57
v_mfma_f32_16x16x32_bf16 v[48:51], v[228:231], v[224:227], v[48:51]
s_add_u32 s65, s9, 589824
s_waitcnt lgkmcnt(0)
v_cmp_eq_u32 vcc, 1, v236
v_readfirstlane_b32 s14, v236
ds_read_b32 v236, v237 offset:29468
s_waitcnt vmcnt(7)
s_cbranch_vccnz L_bo_109
s_waitcnt vmcnt(5)
s_cmp_eq_u32 s14, 3
s_cbranch_scc1 L_bo_109
s_waitcnt vmcnt(4)
L_bo_109:
buffer_load_dwordx4 v[112:115], v1, s[44:47], s65 offen offset:0 nt
v_perm_b32 v228, v135, v131, s56
v_perm_b32 v229, v143, v139, s56
v_perm_b32 v230, v151, v147, s56
v_perm_b32 v231, v159, v155, s56
v_mfma_f32_16x16x32_bf16 v[52:55], v[232:235], v[224:227], v[52:55]
s_waitcnt vmcnt(7)
s_cbranch_vccnz L_bo_110
s_waitcnt vmcnt(5)
s_cmp_eq_u32 s14, 3
s_cbranch_scc1 L_bo_110
s_waitcnt vmcnt(4)
L_bo_110:
buffer_load_dwordx4 v[116:119], v1, s[44:47], s65 offen offset:1024 nt
v_perm_b32 v232, v135, v131, s57
v_perm_b32 v233, v143, v139, s57
v_perm_b32 v234, v151, v147, s57
v_perm_b32 v235, v159, v155, s57
v_mfma_f32_16x16x32_bf16 v[56:59], v[228:231], v[224:227], v[56:59]
s_waitcnt vmcnt(7)
s_cbranch_vccnz L_bo_111
s_waitcnt vmcnt(5)
s_cmp_eq_u32 s14, 3
s_cbranch_scc1 L_bo_111
s_waitcnt vmcnt(4)
L_bo_111:
buffer_load_dwordx4 v[120:123], v1, s[44:47], s65 offen offset:2048 nt
s_nop 1
v_mfma_f32_16x16x32_bf16 v[60:63], v[232:235], v[224:227], v[60:63]
s_waitcnt vmcnt(7)
s_cbranch_vccnz L_bo_112
s_waitcnt vmcnt(5)
s_cmp_eq_u32 s14, 3
s_cbranch_scc1 L_bo_112
s_waitcnt vmcnt(4)
L_bo_112:
buffer_load_dwordx4 v[124:127], v1, s[44:47], s65 offen offset:3072 nt
v_mov_b32 v30, 21
ds_write_b32 v3, v30 offset:28416
v_mov_b32 v224, v11
v_mov_b32_dpp v225, v11 row_ror:12 row_mask:0xf bank_mask:0xf
v_mov_b32_dpp v226, v11 row_ror:8 row_mask:0xf bank_mask:0xf
v_mov_b32_dpp v227, v11 row_ror:4 row_mask:0xf bank_mask:0xf
v_perm_b32 v228, v68, v64, s56
v_perm_b32 v229, v76, v72, s56
v_perm_b32 v230, v84, v80, s56
v_perm_b32 v231, v92, v88, s56
v_perm_b32 v232, v68, v64, s57
v_perm_b32 v233, v76, v72, s57
v_perm_b32 v234, v84, v80, s57
v_perm_b32 v235, v92, v88, s57
v_mfma_f32_16x16x32_bf16 v[32:35], v[228:231], v[224:227], v[32:35]
s_add_u32 s65, s10, 655360
s_waitcnt lgkmcnt(0)
v_cmp_eq_u32 vcc, 1, v236
v_readfirstlane_b32 s14, v236
ds_read_b32 v236, v237 offset:29468
s_waitcnt vmcnt(7)
s_cbranch_vccnz L_bo_113
s_waitcnt vmcnt(5)
s_cmp_eq_u32 s14, 3
s_cbranch_scc1 L_bo_113
s_waitcnt vmcnt(4)
L_bo_113:
buffer_load_dwordx4 v[128:131], v1, s[44:47], s65 offen offset:0 nt
v_perm_b32 v228, v69, v65, s56
v_perm_b32 v229, v77, v73, s56
v_perm_b32 v230, v85, v81, s56
v_perm_b32 v231, v93, v89, s56
v_mfma_f32_16x16x32_bf16 v[36:39], v[232:235], v[224:227], v[36:39]
s_waitcnt vmcnt(7)
s_cbranch_vccnz L_bo_114
s_waitcnt vmcnt(5)
s_cmp_eq_u32 s14, 3
s_cbranch_scc1 L_bo_114
s_waitcnt vmcnt(4)
L_bo_114:
buffer_load_dwordx4 v[132:135], v1, s[44:47], s65 offen offset:1024 nt
v_perm_b32 v232, v69, v65, s57
v_perm_b32 v233, v77, v73, s57
v_perm_b32 v234, v85, v81, s57
v_perm_b32 v235, v93, v89, s57
v_mfma_f32_16x16x32_bf16 v[40:43], v[228:231], v[224:227], v[40:43]
s_waitcnt vmcnt(7)
s_cbranch_vccnz L_bo_115
s_waitcnt vmcnt(5)
s_cmp_eq_u32 s14, 3
s_cbranch_scc1 L_bo_115
s_waitcnt vmcnt(4)
L_bo_115:
buffer_load_dwordx4 v[136:139], v1, s[44:47], s65 offen offset:2048 nt
v_perm_b32 v228, v70, v66, s56
v_perm_b32 v229, v78, v74, s56
v_perm_b32 v230, v86, v82, s56
v_perm_b32 v231, v94, v90, s56
v_mfma_f32_16x16x32_bf16 v[44:47], v[232:235], v[224:227], v[44:47]
s_waitcnt vmcnt(7)
s_cbranch_vccnz L_bo_116
s_waitcnt vmcnt(5)
s_cmp_eq_u32 s14, 3
s_cbranch_scc1 L_bo_116
s_waitcnt vmcnt(4)
L_bo_116:
buffer_load_dwordx4 v[140:143], v1, s[44:47], s65 offen offset:3072 nt
v_perm_b32 v232, v70, v66, s57
v_perm_b32 v233, v78, v74, s57
v_perm_b32 v234, v86, v82, s57
v_perm_b32 v235, v94, v90, s57
v_mfma_f32_16x16x32_bf16 v[48:51], v[228:231], v[224:227], v[48:51]
s_add_u32 s65, s11, 720896
s_waitcnt lgkmcnt(0)
v_cmp_eq_u32 vcc, 1, v236
v_readfirstlane_b32 s14, v236
ds_read_b32 v236, v237 offset:29468
s_waitcnt vmcnt(7)
s_cbranch_vccnz L_bo_117
s_waitcnt vmcnt(5)
s_cmp_eq_u32 s14, 3
s_cbranch_scc1 L_bo_117
s_waitcnt vmcnt(4)
L_bo_117:
buffer_load_dwordx4 v[144:147], v1, s[44:47], s65 offen offset:0 nt
v_perm_b32 v228, v71, v67, s56
v_perm_b32 v229, v79, v75, s56
v_perm_b32 v230, v87, v83, s56
v_perm_b32 v231, v95, v91, s56
v_mfma_f32_16x16x32_bf16 v[52:55], v[232:235], v[224:227], v[52:55]
s_waitcnt vmcnt(7)
s_cbranch_vccnz L_bo_118
s_waitcnt vmcnt(5)
s_cmp_eq_u32 s14, 3
s_cbranch_scc1 L_bo_118
s_waitcnt vmcnt(4)
L_bo_118:
buffer_load_dwordx4 v[148:151], v1, s[44:47], s65 offen offset:1024 nt
v_perm_b32 v232, v71, v67, s57
v_perm_b32 v233, v79, v75, s57
v_perm_b32 v234, v87, v83, s57
v_perm_b32 v235, v95, v91, s57
v_mfma_f32_16x16x32_bf16 v[56:59], v[228:231], v[224:227], v[56:59]
s_waitcnt vmcnt(7)
s_cbranch_vccnz L_bo_119
s_waitcnt vmcnt(5)
s_cmp_eq_u32 s14, 3
s_cbranch_scc1 L_bo_119
s_waitcnt vmcnt(4)
L_bo_119:
buffer_load_dwordx4 v[152:155], v1, s[44:47], s65 offen offset:2048 nt
s_nop 1
v_mfma_f32_16x16x32_bf16 v[60:63], v[232:235], v[224:227], v[60:63]
s_waitcnt vmcnt(7)
s_cbranch_vccnz L_bo_120
s_waitcnt vmcnt(5)
s_cmp_eq_u32 s14, 3
s_cbranch_scc1 L_bo_120
s_waitcnt vmcnt(4)
L_bo_120:
buffer_load_dwordx4 v[156:159], v1, s[44:47], s65 offen offset:3072 nt
v_mov_b32 v30, 22
ds_write_b32 v3, v30 offset:28416
v_mov_b32 v224, v12
v_mov_b32_dpp v225, v12 row_ror:12 row_mask:0xf bank_mask:0xf
v_mov_b32_dpp v226, v12 row_ror:8 row_mask:0xf bank_mask:0xf
v_mov_b32_dpp v227, v12 row_ror:4 row_mask:0xf bank_mask:0xf
v_perm_b32 v228, v100, v96, s56
v_perm_b32 v229, v108, v104, s56
v_perm_b32 v230, v116, v112, s56
v_perm_b32 v231, v124, v120, s56
v_perm_b32 v232, v100, v96, s57
v_perm_b32 v233, v108, v104, s57
v_perm_b32 v234, v116, v112, s57
v_perm_b32 v235, v124, v120, s57
v_mfma_f32_16x16x32_bf16 v[32:35], v[228:231], v[224:227], v[32:35]
s_add_u32 s65, s8, 786432
s_waitcnt lgkmcnt(0)
v_cmp_eq_u32 vcc, 1, v236
v_readfirstlane_b32 s14, v236
ds_read_b32 v236, v237 offset:29468
s_waitcnt vmcnt(7)
s_cbranch_vccnz L_bo_121
s_waitcnt vmcnt(5)
s_cmp_eq_u32 s14, 3
s_cbranch_scc1 L_bo_121
s_waitcnt vmcnt(4)
L_bo_121:
buffer_load_dwordx4 v[64:67], v1, s[44:47], s65 offen offset:0 nt
v_perm_b32 v228, v101, v97, s56
v_perm_b32 v229, v109, v105, s56
v_perm_b32 v230, v117, v113, s56
v_perm_b32 v231, v125, v121, s56
v_mfma_f32_16x16x32_bf16 v[36:39], v[232:235], v[224:227], v[36:39]
s_waitcnt vmcnt(7)
s_cbranch_vccnz L_bo_122
s_waitcnt vmcnt(5)
s_cmp_eq_u32 s14, 3
s_cbranch_scc1 L_bo_122
s_waitcnt vmcnt(4)
L_bo_122:
buffer_load_dwordx4 v[68:71], v1, s[44:47], s65 offen offset:1024 nt
v_perm_b32 v232, v101, v97, s57
v_perm_b32 v233, v109, v105, s57
v_perm_b32 v234, v117, v113, s57
v_perm_b32 v235, v125, v121, s57
v_mfma_f32_16x16x32_bf16 v[40:43], v[228:231], v[224:227], v[40:43]
s_waitcnt vmcnt(7)
s_cbranch_vccnz L_bo_123
s_waitcnt vmcnt(5)
s_cmp_eq_u32 s14, 3
s_cbranch_scc1 L_bo_123
s_waitcnt vmcnt(4)
L_bo_123:
buffer_load_dwordx4 v[72:75], v1, s[44:47], s65 offen offset:2048 nt
v_perm_b32 v228, v102, v98, s56
v_perm_b32 v229, v110, v106, s56
v_perm_b32 v230, v118, v114, s56
v_perm_b32 v231, v126, v122, s56
v_mfma_f32_16x16x32_bf16 v[44:47], v[232:235], v[224:227], v[44:47]
s_waitcnt vmcnt(7)
s_cbranch_vccnz L_bo_124
s_waitcnt vmcnt(5)
s_cmp_eq_u32 s14, 3
s_cbranch_scc1 L_bo_124
s_waitcnt vmcnt(4)
L_bo_124:
buffer_load_dwordx4 v[76:79], v1, s[44:47], s65 offen offset:3072 nt
v_perm_b32 v232, v102, v98, s57
v_perm_b32 v233, v110, v106, s57
v_perm_b32 v234, v118, v114, s57
v_perm_b32 v235, v126, v122, s57
v_mfma_f32_16x16x32_bf16 v[48:51], v[228:231], v[224:227], v[48:51]
s_add_u32 s65, s9, 851968
s_waitcnt lgkmcnt(0)
v_cmp_eq_u32 vcc, 1, v236
v_readfirstlane_b32 s14, v236
ds_read_b32 v236, v237 offset:29468
s_waitcnt vmcnt(7)
s_cbranch_vccnz L_bo_125
s_waitcnt vmcnt(5)
s_cmp_eq_u32 s14, 3
s_cbranch_scc1 L_bo_125
s_waitcnt vmcnt(4)
L_bo_125:
buffer_load_dwordx4 v[80:83], v1, s[44:47], s65 offen offset:0 nt
v_perm_b32 v228, v103, v99, s56
v_perm_b32 v229, v111, v107, s56
v_perm_b32 v230, v119, v115, s56
v_perm_b32 v231, v127, v123, s56
v_mfma_f32_16x16x32_bf16 v[52:55], v[232:235], v[224:227], v[52:55]
s_waitcnt vmcnt(7)
s_cbranch_vccnz L_bo_126
s_waitcnt vmcnt(5)
s_cmp_eq_u32 s14, 3
s_cbranch_scc1 L_bo_126
s_waitcnt vmcnt(4)
L_bo_126:
buffer_load_dwordx4 v[84:87], v1, s[44:47], s65 offen offset:1024 nt
v_perm_b32 v232, v103, v99, s57
v_perm_b32 v233, v111, v107, s57
v_perm_b32 v234, v119, v115, s57
v_perm_b32 v235, v127, v123, s57
v_mfma_f32_16x16x32_bf16 v[56:59], v[228:231], v[224:227], v[56:59]
s_waitcnt vmcnt(7)
s_cbranch_vccnz L_bo_127
s_waitcnt vmcnt(5)
s_cmp_eq_u32 s14, 3
s_cbranch_scc1 L_bo_127
s_waitcnt vmcnt(4)
L_bo_127:
buffer_load_dwordx4 v[88:91], v1, s[44:47], s65 offen offset:2048 nt
s_nop 1
v_mfma_f32_16x16x32_bf16 v[60:63], v[232:235], v[224:227], v[60:63]
s_waitcnt vmcnt(7)
s_cbranch_vccnz L_bo_128
s_waitcnt vmcnt(5)
s_cmp_eq_u32 s14, 3
s_cbranch_scc1 L_bo_128
s_waitcnt vmcnt(4)
L_bo_128:
buffer_load_dwordx4 v[92:95], v1, s[44:47], s65 offen offset:3072 nt
v_mov_b32 v30, 23
ds_write_b32 v3, v30 offset:28416
v_mov_b32 v224, v13
v_mov_b32_dpp v225, v13 row_ror:12 row_mask:0xf bank_mask:0xf
v_mov_b32_dpp v226, v13 row_ror:8 row_mask:0xf bank_mask:0xf
v_mov_b32_dpp v227, v13 row_ror:4 row_mask:0xf bank_mask:0xf
v_perm_b32 v228, v132, v128, s56
v_perm_b32 v229, v140, v136, s56
v_perm_b32 v230, v148, v144, s56
v_perm_b32 v231, v156, v152, s56
v_perm_b32 v232, v132, v128, s57
v_perm_b32 v233, v140, v136, s57
v_perm_b32 v234, v148, v144, s57
v_perm_b32 v235, v156, v152, s57
v_mfma_f32_16x16x32_bf16 v[32:35], v[228:231], v[224:227], v[32:35]
s_add_u32 s65, s10, 917504
s_waitcnt lgkmcnt(0)
v_cmp_eq_u32 vcc, 1, v236
v_readfirstlane_b32 s14, v236
ds_read_b32 v236, v237 offset:29468
s_waitcnt vmcnt(7)
s_cbranch_vccnz L_bo_129
s_waitcnt vmcnt(5)
s_cmp_eq_u32 s14, 3
s_cbranch_scc1 L_bo_129
s_waitcnt vmcnt(4)
L_bo_129:
buffer_load_dwordx4 v[96:99], v1, s[44:47], s65 offen offset:0 nt
v_perm_b32 v228, v133, v129, s56
v_perm_b32 v229, v141, v137, s56
v_perm_b32 v230, v149, v145, s56
v_perm_b32 v231, v157, v153, s56
v_mfma_f32_16x16x32_bf16 v[36:39], v[232:235], v[224:227], v[36:39]
s_waitcnt vmcnt(7)
s_cbranch_vccnz L_bo_130
s_waitcnt vmcnt(5)
s_cmp_eq_u32 s14, 3
s_cbranch_scc1 L_bo_130
s_waitcnt vmcnt(4)
L_bo_130:
buffer_load_dwordx4 v[100:103], v1, s[44:47], s65 offen offset:1024 nt
v_perm_b32 v232, v133, v129, s57
v_perm_b32 v233, v141, v137, s57
v_perm_b32 v234, v149, v145, s57
v_perm_b32 v235, v157, v153, s57
v_mfma_f32_16x16x32_bf16 v[40:43], v[228:231], v[224:227], v[40:43]
s_waitcnt vmcnt(7)
s_cbranch_vccnz L_bo_131
s_waitcnt vmcnt(5)
s_cmp_eq_u32 s14, 3
s_cbranch_scc1 L_bo_131
s_waitcnt vmcnt(4)
L_bo_131:
buffer_load_dwordx4 v[104:107], v1, s[44:47], s65 offen offset:2048 nt
v_perm_b32 v228, v134, v130, s56
v_perm_b32 v229, v142, v138, s56
v_perm_b32 v230, v150, v146, s56
v_perm_b32 v231, v158, v154, s56
v_mfma_f32_16x16x32_bf16 v[44:47], v[232:235], v[224:227], v[44:47]
s_waitcnt vmcnt(7)
s_cbranch_vccnz L_bo_132
s_waitcnt vmcnt(5)
s_cmp_eq_u32 s14, 3
s_cbranch_scc1 L_bo_132
s_waitcnt vmcnt(4)
L_bo_132:
buffer_load_dwordx4 v[108:111], v1, s[44:47], s65 offen offset:3072 nt
v_perm_b32 v232, v134, v130, s57
v_perm_b32 v233, v142, v138, s57
v_perm_b32 v234, v150, v146, s57
v_perm_b32 v235, v158, v154, s57
v_mfma_f32_16x16x32_bf16 v[48:51], v[228:231], v[224:227], v[48:51]
s_add_u32 s65, s11, 983040
s_waitcnt lgkmcnt(0)
v_cmp_eq_u32 vcc, 1, v236
v_readfirstlane_b32 s14, v236
ds_read_b32 v236, v237 offset:29468
s_waitcnt vmcnt(7)
s_cbranch_vccnz L_bo_133
s_waitcnt vmcnt(5)
s_cmp_eq_u32 s14, 3
s_cbranch_scc1 L_bo_133
s_waitcnt vmcnt(4)
L_bo_133:
buffer_load_dwordx4 v[112:115], v1, s[44:47], s65 offen offset:0 nt
v_perm_b32 v228, v135, v131, s56
v_perm_b32 v229, v143, v139, s56
v_perm_b32 v230, v151, v147, s56
v_perm_b32 v231, v159, v155, s56
v_mfma_f32_16x16x32_bf16 v[52:55], v[232:235], v[224:227], v[52:55]
s_waitcnt vmcnt(7)
s_cbranch_vccnz L_bo_134
s_waitcnt vmcnt(5)
s_cmp_eq_u32 s14, 3
s_cbranch_scc1 L_bo_134
s_waitcnt vmcnt(4)
L_bo_134:
buffer_load_dwordx4 v[116:119], v1, s[44:47], s65 offen offset:1024 nt
v_perm_b32 v232, v135, v131, s57
v_perm_b32 v233, v143, v139, s57
v_perm_b32 v234, v151, v147, s57
v_perm_b32 v235, v159, v155, s57
v_mfma_f32_16x16x32_bf16 v[56:59], v[228:231], v[224:227], v[56:59]
s_waitcnt vmcnt(7)
s_cbranch_vccnz L_bo_135
s_waitcnt vmcnt(5)
s_cmp_eq_u32 s14, 3
s_cbranch_scc1 L_bo_135
s_waitcnt vmcnt(4)
L_bo_135:
buffer_load_dwordx4 v[120:123], v1, s[44:47], s65 offen offset:2048 nt
s_nop 1
v_mfma_f32_16x16x32_bf16 v[60:63], v[232:235], v[224:227], v[60:63]
s_waitcnt vmcnt(7)
s_cbranch_vccnz L_bo_136
s_waitcnt vmcnt(5)
s_cmp_eq_u32 s14, 3
s_cbranch_scc1 L_bo_136
s_waitcnt vmcnt(4)
L_bo_136:
buffer_load_dwordx4 v[124:127], v1, s[44:47], s65 offen offset:3072 nt
v_mov_b32 v30, 24
ds_write_b32 v3, v30 offset:28416
v_mov_b32 v224, v20
v_mov_b32_dpp v225, v20 row_ror:12 row_mask:0xf bank_mask:0xf
v_mov_b32_dpp v226, v20 row_ror:8 row_mask:0xf bank_mask:0xf
v_mov_b32_dpp v227, v20 row_ror:4 row_mask:0xf bank_mask:0xf
v_perm_b32 v228, v68, v64, s56
v_perm_b32 v229, v76, v72, s56
v_perm_b32 v230, v84, v80, s56
v_perm_b32 v231, v92, v88, s56
v_perm_b32 v232, v68, v64, s57
v_perm_b32 v233, v76, v72, s57
v_perm_b32 v234, v84, v80, s57
v_perm_b32 v235, v92, v88, s57
v_mfma_f32_16x16x32_bf16 v[32:35], v[228:231], v[224:227], v[32:35]
s_add_u32 s65, s8, 1048576
s_waitcnt lgkmcnt(0)
v_cmp_eq_u32 vcc, 1, v236
v_readfirstlane_b32 s14, v236
ds_read_b32 v236, v237 offset:29468
s_waitcnt vmcnt(7)
s_cbranch_vccnz L_bo_137
s_waitcnt vmcnt(5)
s_cmp_eq_u32 s14, 3
s_cbranch_scc1 L_bo_137
s_waitcnt vmcnt(4)
L_bo_137:
buffer_load_dwordx4 v[128:131], v1, s[44:47], s65 offen offset:0 nt
v_perm_b32 v228, v69, v65, s56
v_perm_b32 v229, v77, v73, s56
v_perm_b32 v230, v85, v81, s56
v_perm_b32 v231, v93, v89, s56
v_mfma_f32_16x16x32_bf16 v[36:39], v[232:235], v[224:227], v[36:39]
s_waitcnt vmcnt(7)
s_cbranch_vccnz L_bo_138
s_waitcnt vmcnt(5)
s_cmp_eq_u32 s14, 3
s_cbranch_scc1 L_bo_138
s_waitcnt vmcnt(4)
L_bo_138:
buffer_load_dwordx4 v[132:135], v1, s[44:47], s65 offen offset:1024 nt
v_perm_b32 v232, v69, v65, s57
v_perm_b32 v233, v77, v73, s57
v_perm_b32 v234, v85, v81, s57
v_perm_b32 v235, v93, v89, s57
v_mfma_f32_16x16x32_bf16 v[40:43], v[228:231], v[224:227], v[40:43]
s_waitcnt vmcnt(7)
s_cbranch_vccnz L_bo_139
s_waitcnt vmcnt(5)
s_cmp_eq_u32 s14, 3
s_cbranch_scc1 L_bo_139
s_waitcnt vmcnt(4)
L_bo_139:
buffer_load_dwordx4 v[136:139], v1, s[44:47], s65 offen offset:2048 nt
v_perm_b32 v228, v70, v66, s56
v_perm_b32 v229, v78, v74, s56
v_perm_b32 v230, v86, v82, s56
v_perm_b32 v231, v94, v90, s56
v_mfma_f32_16x16x32_bf16 v[44:47], v[232:235], v[224:227], v[44:47]
s_waitcnt vmcnt(7)
s_cbranch_vccnz L_bo_140
s_waitcnt vmcnt(5)
s_cmp_eq_u32 s14, 3
s_cbranch_scc1 L_bo_140
s_waitcnt vmcnt(4)
L_bo_140:
buffer_load_dwordx4 v[140:143], v1, s[44:47], s65 offen offset:3072 nt
v_perm_b32 v232, v70, v66, s57
v_perm_b32 v233, v78, v74, s57
v_perm_b32 v234, v86, v82, s57
v_perm_b32 v235, v94, v90, s57
v_mfma_f32_16x16x32_bf16 v[48:51], v[228:231], v[224:227], v[48:51]
s_add_u32 s65, s9, 1114112
s_waitcnt lgkmcnt(0)
v_cmp_eq_u32 vcc, 1, v236
v_readfirstlane_b32 s14, v236
ds_read_b32 v236, v237 offset:29468
s_waitcnt vmcnt(7)
s_cbranch_vccnz L_bo_141
s_waitcnt vmcnt(5)
s_cmp_eq_u32 s14, 3
s_cbranch_scc1 L_bo_141
s_waitcnt vmcnt(4)
L_bo_141:
buffer_load_dwordx4 v[144:147], v1, s[44:47], s65 offen offset:0 nt
v_perm_b32 v228, v71, v67, s56
v_perm_b32 v229, v79, v75, s56
v_perm_b32 v230, v87, v83, s56
v_perm_b32 v231, v95, v91, s56
v_mfma_f32_16x16x32_bf16 v[52:55], v[232:235], v[224:227], v[52:55]
s_waitcnt vmcnt(7)
s_cbranch_vccnz L_bo_142
s_waitcnt vmcnt(5)
s_cmp_eq_u32 s14, 3
s_cbranch_scc1 L_bo_142
s_waitcnt vmcnt(4)
L_bo_142:
buffer_load_dwordx4 v[148:151], v1, s[44:47], s65 offen offset:1024 nt
v_perm_b32 v232, v71, v67, s57
v_perm_b32 v233, v79, v75, s57
v_perm_b32 v234, v87, v83, s57
v_perm_b32 v235, v95, v91, s57
v_mfma_f32_16x16x32_bf16 v[56:59], v[228:231], v[224:227], v[56:59]
s_waitcnt vmcnt(7)
s_cbranch_vccnz L_bo_143
s_waitcnt vmcnt(5)
s_cmp_eq_u32 s14, 3
s_cbranch_scc1 L_bo_143
s_waitcnt vmcnt(4)
L_bo_143:
buffer_load_dwordx4 v[152:155], v1, s[44:47], s65 offen offset:2048 nt
s_nop 1
v_mfma_f32_16x16x32_bf16 v[60:63], v[232:235], v[224:227], v[60:63]
s_waitcnt vmcnt(7)
s_cbranch_vccnz L_bo_144
s_waitcnt vmcnt(5)
s_cmp_eq_u32 s14, 3
s_cbranch_scc1 L_bo_144
s_waitcnt vmcnt(4)
L_bo_144:
buffer_load_dwordx4 v[156:159], v1, s[44:47], s65 offen offset:3072 nt
v_mov_b32 v30, 25
ds_write_b32 v3, v30 offset:28416
v_mov_b32 v224, v21
v_mov_b32_dpp v225, v21 row_ror:12 row_mask:0xf bank_mask:0xf
v_mov_b32_dpp v226, v21 row_ror:8 row_mask:0xf bank_mask:0xf
v_mov_b32_dpp v227, v21 row_ror:4 row_mask:0xf bank_mask:0xf
v_perm_b32 v228, v100, v96, s56
v_perm_b32 v229, v108, v104, s56
v_perm_b32 v230, v116, v112, s56
v_perm_b32 v231, v124, v120, s56
v_perm_b32 v232, v100, v96, s57
v_perm_b32 v233, v108, v104, s57
v_perm_b32 v234, v116, v112, s57
v_perm_b32 v235, v124, v120, s57
v_mfma_f32_16x16x32_bf16 v[32:35], v[228:231], v[224:227], v[32:35]
s_add_u32 s65, s10, 1179648
s_waitcnt lgkmcnt(0)
v_cmp_eq_u32 vcc, 1, v236
v_readfirstlane_b32 s14, v236
ds_read_b32 v236, v237 offset:29468
s_waitcnt vmcnt(7)
s_cbranch_vccnz L_bo_145
s_waitcnt vmcnt(5)
s_cmp_eq_u32 s14, 3
s_cbranch_scc1 L_bo_145
s_waitcnt vmcnt(4)
L_bo_145:
buffer_load_dwordx4 v[64:67], v1, s[44:47], s65 offen offset:0 nt
v_perm_b32 v228, v101, v97, s56
v_perm_b32 v229, v109, v105, s56
v_perm_b32 v230, v117, v113, s56
v_perm_b32 v231, v125, v121, s56
v_mfma_f32_16x16x32_bf16 v[36:39], v[232:235], v[224:227], v[36:39]
s_waitcnt vmcnt(7)
s_cbranch_vccnz L_bo_146
s_waitcnt vmcnt(5)
s_cmp_eq_u32 s14, 3
s_cbranch_scc1 L_bo_146
s_waitcnt vmcnt(4)
L_bo_146:
buffer_load_dwordx4 v[68:71], v1, s[44:47], s65 offen offset:1024 nt
v_perm_b32 v232, v101, v97, s57
v_perm_b32 v233, v109, v105, s57
v_perm_b32 v234, v117, v113, s57
v_perm_b32 v235, v125, v121, s57
v_mfma_f32_16x16x32_bf16 v[40:43], v[228:231], v[224:227], v[40:43]
s_waitcnt vmcnt(7)
s_cbranch_vccnz L_bo_147
s_waitcnt vmcnt(5)
s_cmp_eq_u32 s14, 3
s_cbranch_scc1 L_bo_147
s_waitcnt vmcnt(4)
L_bo_147:
buffer_load_dwordx4 v[72:75], v1, s[44:47], s65 offen offset:2048 nt
v_perm_b32 v228, v102, v98, s56
v_perm_b32 v229, v110, v106, s56
v_perm_b32 v230, v118, v114, s56
v_perm_b32 v231, v126, v122, s56
v_mfma_f32_16x16x32_bf16 v[44:47], v[232:235], v[224:227], v[44:47]
s_waitcnt vmcnt(7)
s_cbranch_vccnz L_bo_148
s_waitcnt vmcnt(5)
s_cmp_eq_u32 s14, 3
s_cbranch_scc1 L_bo_148
s_waitcnt vmcnt(4)
L_bo_148:
buffer_load_dwordx4 v[76:79], v1, s[44:47], s65 offen offset:3072 nt
v_perm_b32 v232, v102, v98, s57
v_perm_b32 v233, v110, v106, s57
v_perm_b32 v234, v118, v114, s57
v_perm_b32 v235, v126, v122, s57
v_mfma_f32_16x16x32_bf16 v[48:51], v[228:231], v[224:227], v[48:51]
s_add_u32 s65, s11, 1245184
s_waitcnt lgkmcnt(0)
v_cmp_eq_u32 vcc, 1, v236
v_readfirstlane_b32 s14, v236
ds_read_b32 v236, v237 offset:29468
s_waitcnt vmcnt(7)
s_cbranch_vccnz L_bo_149
s_waitcnt vmcnt(5)
s_cmp_eq_u32 s14, 3
s_cbranch_scc1 L_bo_149
s_waitcnt vmcnt(4)
L_bo_149:
buffer_load_dwordx4 v[80:83], v1, s[44:47], s65 offen offset:0 nt
v_perm_b32 v228, v103, v99, s56
v_perm_b32 v229, v111, v107, s56
v_perm_b32 v230, v119, v115, s56
v_perm_b32 v231, v127, v123, s56
v_mfma_f32_16x16x32_bf16 v[52:55], v[232:235], v[224:227], v[52:55]
s_waitcnt vmcnt(7)
s_cbranch_vccnz L_bo_150
s_waitcnt vmcnt(5)
s_cmp_eq_u32 s14, 3
s_cbranch_scc1 L_bo_150
s_waitcnt vmcnt(4)
L_bo_150:
buffer_load_dwordx4 v[84:87], v1, s[44:47], s65 offen offset:1024 nt
v_perm_b32 v232, v103, v99, s57
v_perm_b32 v233, v111, v107, s57
v_perm_b32 v234, v119, v115, s57
v_perm_b32 v235, v127, v123, s57
v_mfma_f32_16x16x32_bf16 v[56:59], v[228:231], v[224:227], v[56:59]
s_waitcnt vmcnt(7)
s_cbranch_vccnz L_bo_151
s_waitcnt vmcnt(5)
s_cmp_eq_u32 s14, 3
s_cbranch_scc1 L_bo_151
s_waitcnt vmcnt(4)
L_bo_151:
buffer_load_dwordx4 v[88:91], v1, s[44:47], s65 offen offset:2048 nt
s_nop 1
v_mfma_f32_16x16x32_bf16 v[60:63], v[232:235], v[224:227], v[60:63]
s_waitcnt vmcnt(7)
s_cbranch_vccnz L_bo_152
s_waitcnt vmcnt(5)
s_cmp_eq_u32 s14, 3
s_cbranch_scc1 L_bo_152
s_waitcnt vmcnt(4)
L_bo_152:
buffer_load_dwordx4 v[92:95], v1, s[44:47], s65 offen offset:3072 nt
v_mov_b32 v30, 26
ds_write_b32 v3, v30 offset:28416
v_mov_b32 v224, v22
v_mov_b32_dpp v225, v22 row_ror:12 row_mask:0xf bank_mask:0xf
v_mov_b32_dpp v226, v22 row_ror:8 row_mask:0xf bank_mask:0xf
v_mov_b32_dpp v227, v22 row_ror:4 row_mask:0xf bank_mask:0xf
v_perm_b32 v228, v132, v128, s56
v_perm_b32 v229, v140, v136, s56
v_perm_b32 v230, v148, v144, s56
v_perm_b32 v231, v156, v152, s56
v_perm_b32 v232, v132, v128, s57
v_perm_b32 v233, v140, v136, s57
v_perm_b32 v234, v148, v144, s57
v_perm_b32 v235, v156, v152, s57
v_mfma_f32_16x16x32_bf16 v[32:35], v[228:231], v[224:227], v[32:35]
s_add_u32 s65, s8, 1310720
s_waitcnt lgkmcnt(0)
v_cmp_eq_u32 vcc, 1, v236
v_readfirstlane_b32 s14, v236
ds_read_b32 v236, v237 offset:29468
s_waitcnt vmcnt(7)
s_cbranch_vccnz L_bo_153
s_waitcnt vmcnt(5)
s_cmp_eq_u32 s14, 3
s_cbranch_scc1 L_bo_153
s_waitcnt vmcnt(4)
L_bo_153:
buffer_load_dwordx4 v[96:99], v1, s[44:47], s65 offen offset:0 nt
v_perm_b32 v228, v133, v129, s56
v_perm_b32 v229, v141, v137, s56
v_perm_b32 v230, v149, v145, s56
v_perm_b32 v231, v157, v153, s56
v_mfma_f32_16x16x32_bf16 v[36:39], v[232:235], v[224:227], v[36:39]
s_waitcnt vmcnt(7)
s_cbranch_vccnz L_bo_154
s_waitcnt vmcnt(5)
s_cmp_eq_u32 s14, 3
s_cbranch_scc1 L_bo_154
s_waitcnt vmcnt(4)
L_bo_154:
buffer_load_dwordx4 v[100:103], v1, s[44:47], s65 offen offset:1024 nt
v_perm_b32 v232, v133, v129, s57
v_perm_b32 v233, v141, v137, s57
v_perm_b32 v234, v149, v145, s57
v_perm_b32 v235, v157, v153, s57
v_mfma_f32_16x16x32_bf16 v[40:43], v[228:231], v[224:227], v[40:43]
s_waitcnt vmcnt(7)
s_cbranch_vccnz L_bo_155
s_waitcnt vmcnt(5)
s_cmp_eq_u32 s14, 3
s_cbranch_scc1 L_bo_155
s_waitcnt vmcnt(4)
L_bo_155:
buffer_load_dwordx4 v[104:107], v1, s[44:47], s65 offen offset:2048 nt
v_perm_b32 v228, v134, v130, s56
v_perm_b32 v229, v142, v138, s56
v_perm_b32 v230, v150, v146, s56
v_perm_b32 v231, v158, v154, s56
v_mfma_f32_16x16x32_bf16 v[44:47], v[232:235], v[224:227], v[44:47]
s_waitcnt vmcnt(7)
s_cbranch_vccnz L_bo_156
s_waitcnt vmcnt(5)
s_cmp_eq_u32 s14, 3
s_cbranch_scc1 L_bo_156
s_waitcnt vmcnt(4)
L_bo_156:
buffer_load_dwordx4 v[108:111], v1, s[44:47], s65 offen offset:3072 nt
v_perm_b32 v232, v134, v130, s57
v_perm_b32 v233, v142, v138, s57
v_perm_b32 v234, v150, v146, s57
v_perm_b32 v235, v158, v154, s57
v_mfma_f32_16x16x32_bf16 v[48:51], v[228:231], v[224:227], v[48:51]
s_add_u32 s65, s9, 1376256
s_waitcnt lgkmcnt(0)
v_cmp_eq_u32 vcc, 1, v236
v_readfirstlane_b32 s14, v236
ds_read_b32 v236, v237 offset:29468
s_waitcnt vmcnt(7)
s_cbranch_vccnz L_bo_157
s_waitcnt vmcnt(5)
s_cmp_eq_u32 s14, 3
s_cbranch_scc1 L_bo_157
s_waitcnt vmcnt(4)
L_bo_157:
buffer_load_dwordx4 v[112:115], v1, s[44:47], s65 offen offset:0 nt
v_perm_b32 v228, v135, v131, s56
v_perm_b32 v229, v143, v139, s56
v_perm_b32 v230, v151, v147, s56
v_perm_b32 v231, v159, v155, s56
v_mfma_f32_16x16x32_bf16 v[52:55], v[232:235], v[224:227], v[52:55]
s_waitcnt vmcnt(7)
s_cbranch_vccnz L_bo_158
s_waitcnt vmcnt(5)
s_cmp_eq_u32 s14, 3
s_cbranch_scc1 L_bo_158
s_waitcnt vmcnt(4)
L_bo_158:
buffer_load_dwordx4 v[116:119], v1, s[44:47], s65 offen offset:1024 nt
v_perm_b32 v232, v135, v131, s57
v_perm_b32 v233, v143, v139, s57
v_perm_b32 v234, v151, v147, s57
v_perm_b32 v235, v159, v155, s57
v_mfma_f32_16x16x32_bf16 v[56:59], v[228:231], v[224:227], v[56:59]
s_waitcnt vmcnt(7)
s_cbranch_vccnz L_bo_159
s_waitcnt vmcnt(5)
s_cmp_eq_u32 s14, 3
s_cbranch_scc1 L_bo_159
s_waitcnt vmcnt(4)
L_bo_159:
buffer_load_dwordx4 v[120:123], v1, s[44:47], s65 offen offset:2048 nt
s_nop 1
v_mfma_f32_16x16x32_bf16 v[60:63], v[232:235], v[224:227], v[60:63]
s_waitcnt vmcnt(7)
s_cbranch_vccnz L_bo_160
s_waitcnt vmcnt(5)
s_cmp_eq_u32 s14, 3
s_cbranch_scc1 L_bo_160
s_waitcnt vmcnt(4)
L_bo_160:
buffer_load_dwordx4 v[124:127], v1, s[44:47], s65 offen offset:3072 nt
v_mov_b32 v30, 27
ds_write_b32 v3, v30 offset:28416
v_mov_b32 v224, v23
v_mov_b32_dpp v225, v23 row_ror:12 row_mask:0xf bank_mask:0xf
v_mov_b32_dpp v226, v23 row_ror:8 row_mask:0xf bank_mask:0xf
v_mov_b32_dpp v227, v23 row_ror:4 row_mask:0xf bank_mask:0xf
v_perm_b32 v228, v68, v64, s56
v_perm_b32 v229, v76, v72, s56
v_perm_b32 v230, v84, v80, s56
v_perm_b32 v231, v92, v88, s56
v_perm_b32 v232, v68, v64, s57
v_perm_b32 v233, v76, v72, s57
v_perm_b32 v234, v84, v80, s57
v_perm_b32 v235, v92, v88, s57
v_mfma_f32_16x16x32_bf16 v[32:35], v[228:231], v[224:227], v[32:35]
s_add_u32 s65, s10, 1441792
s_waitcnt lgkmcnt(0)
v_cmp_eq_u32 vcc, 1, v236
v_readfirstlane_b32 s14, v236
ds_read_b32 v236, v237 offset:29468
s_waitcnt vmcnt(7)
s_cbranch_vccnz L_bo_161
s_waitcnt vmcnt(5)
s_cmp_eq_u32 s14, 3
s_cbranch_scc1 L_bo_161
s_waitcnt vmcnt(4)
L_bo_161:
buffer_load_dwordx4 v[128:131], v1, s[44:47], s65 offen offset:0 nt
v_perm_b32 v228, v69, v65, s56
v_perm_b32 v229, v77, v73, s56
v_perm_b32 v230, v85, v81, s56
v_perm_b32 v231, v93, v89, s56
v_mfma_f32_16x16x32_bf16 v[36:39], v[232:235], v[224:227], v[36:39]
s_waitcnt vmcnt(7)
s_cbranch_vccnz L_bo_162
s_waitcnt vmcnt(5)
s_cmp_eq_u32 s14, 3
s_cbranch_scc1 L_bo_162
s_waitcnt vmcnt(4)
L_bo_162:
buffer_load_dwordx4 v[132:135], v1, s[44:47], s65 offen offset:1024 nt
v_perm_b32 v232, v69, v65, s57
v_perm_b32 v233, v77, v73, s57
v_perm_b32 v234, v85, v81, s57
v_perm_b32 v235, v93, v89, s57
v_mfma_f32_16x16x32_bf16 v[40:43], v[228:231], v[224:227], v[40:43]
s_waitcnt vmcnt(7)
s_cbranch_vccnz L_bo_163
s_waitcnt vmcnt(5)
s_cmp_eq_u32 s14, 3
s_cbranch_scc1 L_bo_163
s_waitcnt vmcnt(4)
L_bo_163:
buffer_load_dwordx4 v[136:139], v1, s[44:47], s65 offen offset:2048 nt
v_perm_b32 v228, v70, v66, s56
v_perm_b32 v229, v78, v74, s56
v_perm_b32 v230, v86, v82, s56
v_perm_b32 v231, v94, v90, s56
v_mfma_f32_16x16x32_bf16 v[44:47], v[232:235], v[224:227], v[44:47]
s_waitcnt vmcnt(7)
s_cbranch_vccnz L_bo_164
s_waitcnt vmcnt(5)
s_cmp_eq_u32 s14, 3
s_cbranch_scc1 L_bo_164
s_waitcnt vmcnt(4)
L_bo_164:
buffer_load_dwordx4 v[140:143], v1, s[44:47], s65 offen offset:3072 nt
v_perm_b32 v232, v70, v66, s57
v_perm_b32 v233, v78, v74, s57
v_perm_b32 v234, v86, v82, s57
v_perm_b32 v235, v94, v90, s57
v_mfma_f32_16x16x32_bf16 v[48:51], v[228:231], v[224:227], v[48:51]
s_add_u32 s65, s11, 1507328
s_waitcnt lgkmcnt(0)
v_cmp_eq_u32 vcc, 1, v236
v_readfirstlane_b32 s14, v236
ds_read_b32 v236, v237 offset:29468
s_waitcnt vmcnt(7)
s_cbranch_vccnz L_bo_165
s_waitcnt vmcnt(5)
s_cmp_eq_u32 s14, 3
s_cbranch_scc1 L_bo_165
s_waitcnt vmcnt(4)
L_bo_165:
buffer_load_dwordx4 v[144:147], v1, s[44:47], s65 offen offset:0 nt
v_perm_b32 v228, v71, v67, s56
v_perm_b32 v229, v79, v75, s56
v_perm_b32 v230, v87, v83, s56
v_perm_b32 v231, v95, v91, s56
v_mfma_f32_16x16x32_bf16 v[52:55], v[232:235], v[224:227], v[52:55]
s_waitcnt vmcnt(7)
s_cbranch_vccnz L_bo_166
s_waitcnt vmcnt(5)
s_cmp_eq_u32 s14, 3
s_cbranch_scc1 L_bo_166
s_waitcnt vmcnt(4)
L_bo_166:
buffer_load_dwordx4 v[148:151], v1, s[44:47], s65 offen offset:1024 nt
v_perm_b32 v232, v71, v67, s57
v_perm_b32 v233, v79, v75, s57
v_perm_b32 v234, v87, v83, s57
v_perm_b32 v235, v95, v91, s57
v_mfma_f32_16x16x32_bf16 v[56:59], v[228:231], v[224:227], v[56:59]
s_waitcnt vmcnt(7)
s_cbranch_vccnz L_bo_167
s_waitcnt vmcnt(5)
s_cmp_eq_u32 s14, 3
s_cbranch_scc1 L_bo_167
s_waitcnt vmcnt(4)
L_bo_167:
buffer_load_dwordx4 v[152:155], v1, s[44:47], s65 offen offset:2048 nt
s_nop 1
v_mfma_f32_16x16x32_bf16 v[60:63], v[232:235], v[224:227], v[60:63]
s_waitcnt vmcnt(7)
s_cbranch_vccnz L_bo_168
s_waitcnt vmcnt(5)
s_cmp_eq_u32 s14, 3
s_cbranch_scc1 L_bo_168
s_waitcnt vmcnt(4)
L_bo_168:
buffer_load_dwordx4 v[156:159], v1, s[44:47], s65 offen offset:3072 nt
v_mov_b32 v30, 28
ds_write_b32 v3, v30 offset:28416
v_mov_b32 v224, v25
v_mov_b32_dpp v225, v25 row_ror:12 row_mask:0xf bank_mask:0xf
v_mov_b32_dpp v226, v25 row_ror:8 row_mask:0xf bank_mask:0xf
v_mov_b32_dpp v227, v25 row_ror:4 row_mask:0xf bank_mask:0xf
v_perm_b32 v228, v100, v96, s56
v_perm_b32 v229, v108, v104, s56
v_perm_b32 v230, v116, v112, s56
v_perm_b32 v231, v124, v120, s56
v_perm_b32 v232, v100, v96, s57
v_perm_b32 v233, v108, v104, s57
v_perm_b32 v234, v116, v112, s57
v_perm_b32 v235, v124, v120, s57
v_mfma_f32_16x16x32_bf16 v[32:35], v[228:231], v[224:227], v[32:35]
s_add_u32 s65, s8, 1572864
s_waitcnt lgkmcnt(0)
v_cmp_eq_u32 vcc, 1, v236
v_readfirstlane_b32 s14, v236
ds_read_b32 v236, v237 offset:29468
s_waitcnt vmcnt(7)
s_cbranch_vccnz L_bo_169
s_waitcnt vmcnt(5)
s_cmp_eq_u32 s14, 3
s_cbranch_scc1 L_bo_169
s_waitcnt vmcnt(4)
L_bo_169:
buffer_load_dwordx4 v[64:67], v1, s[44:47], s65 offen offset:0 nt
v_perm_b32 v228, v101, v97, s56
v_perm_b32 v229, v109, v105, s56
v_perm_b32 v230, v117, v113, s56
v_perm_b32 v231, v125, v121, s56
v_mfma_f32_16x16x32_bf16 v[36:39], v[232:235], v[224:227], v[36:39]
s_waitcnt vmcnt(7)
s_cbranch_vccnz L_bo_170
s_waitcnt vmcnt(5)
s_cmp_eq_u32 s14, 3
s_cbranch_scc1 L_bo_170
s_waitcnt vmcnt(4)
L_bo_170:
buffer_load_dwordx4 v[68:71], v1, s[44:47], s65 offen offset:1024 nt
v_perm_b32 v232, v101, v97, s57
v_perm_b32 v233, v109, v105, s57
v_perm_b32 v234, v117, v113, s57
v_perm_b32 v235, v125, v121, s57
v_mfma_f32_16x16x32_bf16 v[40:43], v[228:231], v[224:227], v[40:43]
s_waitcnt vmcnt(7)
s_cbranch_vccnz L_bo_171
s_waitcnt vmcnt(5)
s_cmp_eq_u32 s14, 3
s_cbranch_scc1 L_bo_171
s_waitcnt vmcnt(4)
L_bo_171:
buffer_load_dwordx4 v[72:75], v1, s[44:47], s65 offen offset:2048 nt
v_perm_b32 v228, v102, v98, s56
v_perm_b32 v229, v110, v106, s56
v_perm_b32 v230, v118, v114, s56
v_perm_b32 v231, v126, v122, s56
v_mfma_f32_16x16x32_bf16 v[44:47], v[232:235], v[224:227], v[44:47]
s_waitcnt vmcnt(7)
s_cbranch_vccnz L_bo_172
s_waitcnt vmcnt(5)
s_cmp_eq_u32 s14, 3
s_cbranch_scc1 L_bo_172
s_waitcnt vmcnt(4)
L_bo_172:
buffer_load_dwordx4 v[76:79], v1, s[44:47], s65 offen offset:3072 nt
v_perm_b32 v232, v102, v98, s57
v_perm_b32 v233, v110, v106, s57
v_perm_b32 v234, v118, v114, s57
v_perm_b32 v235, v126, v122, s57
v_mfma_f32_16x16x32_bf16 v[48:51], v[228:231], v[224:227], v[48:51]
s_add_u32 s65, s9, 1638400
s_waitcnt lgkmcnt(0)
v_cmp_eq_u32 vcc, 1, v236
v_readfirstlane_b32 s14, v236
ds_read_b32 v236, v237 offset:29468
s_waitcnt vmcnt(7)
s_cbranch_vccnz L_bo_173
s_waitcnt vmcnt(5)
s_cmp_eq_u32 s14, 3
s_cbranch_scc1 L_bo_173
s_waitcnt vmcnt(4)
L_bo_173:
buffer_load_dwordx4 v[80:83], v1, s[44:47], s65 offen offset:0 nt
v_perm_b32 v228, v103, v99, s56
v_perm_b32 v229, v111, v107, s56
v_perm_b32 v230, v119, v115, s56
v_perm_b32 v231, v127, v123, s56
v_mfma_f32_16x16x32_bf16 v[52:55], v[232:235], v[224:227], v[52:55]
s_waitcnt vmcnt(7)
s_cbranch_vccnz L_bo_174
s_waitcnt vmcnt(5)
s_cmp_eq_u32 s14, 3
s_cbranch_scc1 L_bo_174
s_waitcnt vmcnt(4)
L_bo_174:
buffer_load_dwordx4 v[84:87], v1, s[44:47], s65 offen offset:1024 nt
v_perm_b32 v232, v103, v99, s57
v_perm_b32 v233, v111, v107, s57
v_perm_b32 v234, v119, v115, s57
v_perm_b32 v235, v127, v123, s57
v_mfma_f32_16x16x32_bf16 v[56:59], v[228:231], v[224:227], v[56:59]
s_waitcnt vmcnt(7)
s_cbranch_vccnz L_bo_175
s_waitcnt vmcnt(5)
s_cmp_eq_u32 s14, 3
s_cbranch_scc1 L_bo_175
s_waitcnt vmcnt(4)
L_bo_175:
buffer_load_dwordx4 v[88:91], v1, s[44:47], s65 offen offset:2048 nt
s_nop 1
v_mfma_f32_16x16x32_bf16 v[60:63], v[232:235], v[224:227], v[60:63]
s_waitcnt vmcnt(7)
s_cbranch_vccnz L_bo_176
s_waitcnt vmcnt(5)
s_cmp_eq_u32 s14, 3
s_cbranch_scc1 L_bo_176
s_waitcnt vmcnt(4)
L_bo_176:
buffer_load_dwordx4 v[92:95], v1, s[44:47], s65 offen offset:3072 nt
v_mov_b32 v30, 29
ds_write_b32 v3, v30 offset:28416
v_mov_b32 v224, v26
v_mov_b32_dpp v225, v26 row_ror:12 row_mask:0xf bank_mask:0xf
v_mov_b32_dpp v226, v26 row_ror:8 row_mask:0xf bank_mask:0xf
v_mov_b32_dpp v227, v26 row_ror:4 row_mask:0xf bank_mask:0xf
v_perm_b32 v228, v132, v128, s56
v_perm_b32 v229, v140, v136, s56
v_perm_b32 v230, v148, v144, s56
v_perm_b32 v231, v156, v152, s56
v_perm_b32 v232, v132, v128, s57
v_perm_b32 v233, v140, v136, s57
v_perm_b32 v234, v148, v144, s57
v_perm_b32 v235, v156, v152, s57
v_mfma_f32_16x16x32_bf16 v[32:35], v[228:231], v[224:227], v[32:35]
s_add_u32 s65, s10, 1703936
s_waitcnt lgkmcnt(0)
v_cmp_eq_u32 vcc, 1, v236
v_readfirstlane_b32 s14, v236
ds_read_b32 v236, v237 offset:29468
s_waitcnt vmcnt(7)
s_cbranch_vccnz L_bo_177
s_waitcnt vmcnt(5)
s_cmp_eq_u32 s14, 3
s_cbranch_scc1 L_bo_177
s_waitcnt vmcnt(4)
L_bo_177:
buffer_load_dwordx4 v[96:99], v1, s[44:47], s65 offen offset:0 nt
v_perm_b32 v228, v133, v129, s56
v_perm_b32 v229, v141, v137, s56
v_perm_b32 v230, v149, v145, s56
v_perm_b32 v231, v157, v153, s56
v_mfma_f32_16x16x32_bf16 v[36:39], v[232:235], v[224:227], v[36:39]
s_waitcnt vmcnt(7)
s_cbranch_vccnz L_bo_178
s_waitcnt vmcnt(5)
s_cmp_eq_u32 s14, 3
s_cbranch_scc1 L_bo_178
s_waitcnt vmcnt(4)
L_bo_178:
buffer_load_dwordx4 v[100:103], v1, s[44:47], s65 offen offset:1024 nt
v_perm_b32 v232, v133, v129, s57
v_perm_b32 v233, v141, v137, s57
v_perm_b32 v234, v149, v145, s57
v_perm_b32 v235, v157, v153, s57
v_mfma_f32_16x16x32_bf16 v[40:43], v[228:231], v[224:227], v[40:43]
s_waitcnt vmcnt(7)
s_cbranch_vccnz L_bo_179
s_waitcnt vmcnt(5)
s_cmp_eq_u32 s14, 3
s_cbranch_scc1 L_bo_179
s_waitcnt vmcnt(4)
L_bo_179:
buffer_load_dwordx4 v[104:107], v1, s[44:47], s65 offen offset:2048 nt
v_perm_b32 v228, v134, v130, s56
v_perm_b32 v229, v142, v138, s56
v_perm_b32 v230, v150, v146, s56
v_perm_b32 v231, v158, v154, s56
v_mfma_f32_16x16x32_bf16 v[44:47], v[232:235], v[224:227], v[44:47]
s_waitcnt vmcnt(7)
s_cbranch_vccnz L_bo_180
s_waitcnt vmcnt(5)
s_cmp_eq_u32 s14, 3
s_cbranch_scc1 L_bo_180
s_waitcnt vmcnt(4)
L_bo_180:
buffer_load_dwordx4 v[108:111], v1, s[44:47], s65 offen offset:3072 nt
v_perm_b32 v232, v134, v130, s57
v_perm_b32 v233, v142, v138, s57
v_perm_b32 v234, v150, v146, s57
v_perm_b32 v235, v158, v154, s57
v_mfma_f32_16x16x32_bf16 v[48:51], v[228:231], v[224:227], v[48:51]
s_add_u32 s65, s11, 1769472
s_waitcnt lgkmcnt(0)
v_cmp_eq_u32 vcc, 1, v236
v_readfirstlane_b32 s14, v236
ds_read_b32 v236, v237 offset:29468
s_waitcnt vmcnt(7)
s_cbranch_vccnz L_bo_181
s_waitcnt vmcnt(5)
s_cmp_eq_u32 s14, 3
s_cbranch_scc1 L_bo_181
s_waitcnt vmcnt(4)
L_bo_181:
buffer_load_dwordx4 v[112:115], v1, s[44:47], s65 offen offset:0 nt
v_perm_b32 v228, v135, v131, s56
v_perm_b32 v229, v143, v139, s56
v_perm_b32 v230, v151, v147, s56
v_perm_b32 v231, v159, v155, s56
v_mfma_f32_16x16x32_bf16 v[52:55], v[232:235], v[224:227], v[52:55]
s_waitcnt vmcnt(7)
s_cbranch_vccnz L_bo_182
s_waitcnt vmcnt(5)
s_cmp_eq_u32 s14, 3
s_cbranch_scc1 L_bo_182
s_waitcnt vmcnt(4)
L_bo_182:
buffer_load_dwordx4 v[116:119], v1, s[44:47], s65 offen offset:1024 nt
v_perm_b32 v232, v135, v131, s57
v_perm_b32 v233, v143, v139, s57
v_perm_b32 v234, v151, v147, s57
v_perm_b32 v235, v159, v155, s57
v_mfma_f32_16x16x32_bf16 v[56:59], v[228:231], v[224:227], v[56:59]
s_waitcnt vmcnt(7)
s_cbranch_vccnz L_bo_183
s_waitcnt vmcnt(5)
s_cmp_eq_u32 s14, 3
s_cbranch_scc1 L_bo_183
s_waitcnt vmcnt(4)
L_bo_183:
buffer_load_dwordx4 v[120:123], v1, s[44:47], s65 offen offset:2048 nt
s_nop 1
v_mfma_f32_16x16x32_bf16 v[60:63], v[232:235], v[224:227], v[60:63]
s_waitcnt vmcnt(7)
s_cbranch_vccnz L_bo_184
s_waitcnt vmcnt(5)
s_cmp_eq_u32 s14, 3
s_cbranch_scc1 L_bo_184
s_waitcnt vmcnt(4)
L_bo_184:
buffer_load_dwordx4 v[124:127], v1, s[44:47], s65 offen offset:3072 nt
v_mov_b32 v30, 30
ds_write_b32 v3, v30 offset:28416
v_mov_b32 v224, v27
v_mov_b32_dpp v225, v27 row_ror:12 row_mask:0xf bank_mask:0xf
v_mov_b32_dpp v226, v27 row_ror:8 row_mask:0xf bank_mask:0xf
v_mov_b32_dpp v227, v27 row_ror:4 row_mask:0xf bank_mask:0xf
v_perm_b32 v228, v68, v64, s56
v_perm_b32 v229, v76, v72, s56
v_perm_b32 v230, v84, v80, s56
v_perm_b32 v231, v92, v88, s56
v_perm_b32 v232, v68, v64, s57
v_perm_b32 v233, v76, v72, s57
v_perm_b32 v234, v84, v80, s57
v_perm_b32 v235, v92, v88, s57
v_mfma_f32_16x16x32_bf16 v[32:35], v[228:231], v[224:227], v[32:35]
s_add_u32 s65, s8, 1835008
s_waitcnt lgkmcnt(0)
v_cmp_eq_u32 vcc, 1, v236
v_readfirstlane_b32 s14, v236
ds_read_b32 v236, v237 offset:29468
s_waitcnt vmcnt(7)
s_cbranch_vccnz L_bo_185
s_waitcnt vmcnt(5)
s_cmp_eq_u32 s14, 3
s_cbranch_scc1 L_bo_185
s_waitcnt vmcnt(4)
L_bo_185:
buffer_load_dwordx4 v[128:131], v1, s[44:47], s65 offen offset:0 nt
v_perm_b32 v228, v69, v65, s56
v_perm_b32 v229, v77, v73, s56
v_perm_b32 v230, v85, v81, s56
v_perm_b32 v231, v93, v89, s56
v_mfma_f32_16x16x32_bf16 v[36:39], v[232:235], v[224:227], v[36:39]
s_waitcnt vmcnt(7)
s_cbranch_vccnz L_bo_186
s_waitcnt vmcnt(5)
s_cmp_eq_u32 s14, 3
s_cbranch_scc1 L_bo_186
s_waitcnt vmcnt(4)
L_bo_186:
buffer_load_dwordx4 v[132:135], v1, s[44:47], s65 offen offset:1024 nt
v_perm_b32 v232, v69, v65, s57
v_perm_b32 v233, v77, v73, s57
v_perm_b32 v234, v85, v81, s57
v_perm_b32 v235, v93, v89, s57
v_mfma_f32_16x16x32_bf16 v[40:43], v[228:231], v[224:227], v[40:43]
s_waitcnt vmcnt(7)
s_cbranch_vccnz L_bo_187
s_waitcnt vmcnt(5)
s_cmp_eq_u32 s14, 3
s_cbranch_scc1 L_bo_187
s_waitcnt vmcnt(4)
L_bo_187:
buffer_load_dwordx4 v[136:139], v1, s[44:47], s65 offen offset:2048 nt
v_perm_b32 v228, v70, v66, s56
v_perm_b32 v229, v78, v74, s56
v_perm_b32 v230, v86, v82, s56
v_perm_b32 v231, v94, v90, s56
v_mfma_f32_16x16x32_bf16 v[44:47], v[232:235], v[224:227], v[44:47]
s_waitcnt vmcnt(7)
s_cbranch_vccnz L_bo_188
s_waitcnt vmcnt(5)
s_cmp_eq_u32 s14, 3
s_cbranch_scc1 L_bo_188
s_waitcnt vmcnt(4)
L_bo_188:
buffer_load_dwordx4 v[140:143], v1, s[44:47], s65 offen offset:3072 nt
v_perm_b32 v232, v70, v66, s57
v_perm_b32 v233, v78, v74, s57
v_perm_b32 v234, v86, v82, s57
v_perm_b32 v235, v94, v90, s57
v_mfma_f32_16x16x32_bf16 v[48:51], v[228:231], v[224:227], v[48:51]
s_add_u32 s65, s9, 1900544
s_waitcnt lgkmcnt(0)
v_cmp_eq_u32 vcc, 1, v236
v_readfirstlane_b32 s14, v236
ds_read_b32 v236, v237 offset:29468
s_waitcnt vmcnt(7)
s_cbranch_vccnz L_bo_189
s_waitcnt vmcnt(5)
s_cmp_eq_u32 s14, 3
s_cbranch_scc1 L_bo_189
s_waitcnt vmcnt(4)
L_bo_189:
buffer_load_dwordx4 v[144:147], v1, s[44:47], s65 offen offset:0 nt
v_perm_b32 v228, v71, v67, s56
v_perm_b32 v229, v79, v75, s56
v_perm_b32 v230, v87, v83, s56
v_perm_b32 v231, v95, v91, s56
v_mfma_f32_16x16x32_bf16 v[52:55], v[232:235], v[224:227], v[52:55]
s_waitcnt vmcnt(7)
s_cbranch_vccnz L_bo_190
s_waitcnt vmcnt(5)
s_cmp_eq_u32 s14, 3
s_cbranch_scc1 L_bo_190
s_waitcnt vmcnt(4)
L_bo_190:
buffer_load_dwordx4 v[148:151], v1, s[44:47], s65 offen offset:1024 nt
v_perm_b32 v232, v71, v67, s57
v_perm_b32 v233, v79, v75, s57
v_perm_b32 v234, v87, v83, s57
v_perm_b32 v235, v95, v91, s57
v_mfma_f32_16x16x32_bf16 v[56:59], v[228:231], v[224:227], v[56:59]
s_waitcnt vmcnt(7)
s_cbranch_vccnz L_bo_191
s_waitcnt vmcnt(5)
s_cmp_eq_u32 s14, 3
s_cbranch_scc1 L_bo_191
s_waitcnt vmcnt(4)
L_bo_191:
buffer_load_dwordx4 v[152:155], v1, s[44:47], s65 offen offset:2048 nt
s_nop 1
v_mfma_f32_16x16x32_bf16 v[60:63], v[232:235], v[224:227], v[60:63]
s_waitcnt vmcnt(7)
s_cbranch_vccnz L_bo_192
s_waitcnt vmcnt(5)
s_cmp_eq_u32 s14, 3
s_cbranch_scc1 L_bo_192
s_waitcnt vmcnt(4)
L_bo_192:
buffer_load_dwordx4 v[156:159], v1, s[44:47], s65 offen offset:3072 nt
v_mov_b32 v30, 31
ds_write_b32 v3, v30 offset:28416
v_mov_b32 v224, v28
v_mov_b32_dpp v225, v28 row_ror:12 row_mask:0xf bank_mask:0xf
v_mov_b32_dpp v226, v28 row_ror:8 row_mask:0xf bank_mask:0xf
v_mov_b32_dpp v227, v28 row_ror:4 row_mask:0xf bank_mask:0xf
v_perm_b32 v228, v100, v96, s56
v_perm_b32 v229, v108, v104, s56
v_perm_b32 v230, v116, v112, s56
v_perm_b32 v231, v124, v120, s56
v_perm_b32 v232, v100, v96, s57
v_perm_b32 v233, v108, v104, s57
v_perm_b32 v234, v116, v112, s57
v_perm_b32 v235, v124, v120, s57
v_mfma_f32_16x16x32_bf16 v[32:35], v[228:231], v[224:227], v[32:35]
s_add_u32 s65, s10, 1966080
s_waitcnt lgkmcnt(0)
v_cmp_eq_u32 vcc, 1, v236
v_readfirstlane_b32 s14, v236
ds_read_b32 v236, v237 offset:29468
s_waitcnt vmcnt(14)
s_cbranch_vccnz L_bo_193
s_waitcnt vmcnt(12)
s_cmp_eq_u32 s14, 3
s_cbranch_scc1 L_bo_193
s_waitcnt vmcnt(11)
L_bo_193:
buffer_load_dwordx4 v[64:67], v1, s[44:47], s65 offen offset:0 nt
v_perm_b32 v228, v101, v97, s56
v_perm_b32 v229, v109, v105, s56
v_perm_b32 v230, v117, v113, s56
v_perm_b32 v231, v125, v121, s56
v_mfma_f32_16x16x32_bf16 v[36:39], v[232:235], v[224:227], v[36:39]
s_waitcnt vmcnt(14)
s_cbranch_vccnz L_bo_194
s_waitcnt vmcnt(12)
s_cmp_eq_u32 s14, 3
s_cbranch_scc1 L_bo_194
s_waitcnt vmcnt(11)
L_bo_194:
buffer_load_dwordx4 v[68:71], v1, s[44:47], s65 offen offset:1024 nt
v_perm_b32 v232, v101, v97, s57
v_perm_b32 v233, v109, v105, s57
v_perm_b32 v234, v117, v113, s57
v_perm_b32 v235, v125, v121, s57
v_mfma_f32_16x16x32_bf16 v[40:43], v[228:231], v[224:227], v[40:43]
s_waitcnt vmcnt(14)
s_cbranch_vccnz L_bo_195
s_waitcnt vmcnt(12)
s_cmp_eq_u32 s14, 3
s_cbranch_scc1 L_bo_195
s_waitcnt vmcnt(11)
L_bo_195:
buffer_load_dwordx4 v[72:75], v1, s[44:47], s65 offen offset:2048 nt
v_perm_b32 v228, v102, v98, s56
v_perm_b32 v229, v110, v106, s56
v_perm_b32 v230, v118, v114, s56
v_perm_b32 v231, v126, v122, s56
v_mfma_f32_16x16x32_bf16 v[44:47], v[232:235], v[224:227], v[44:47]
s_waitcnt vmcnt(14)
s_cbranch_vccnz L_bo_196
s_waitcnt vmcnt(12)
s_cmp_eq_u32 s14, 3
s_cbranch_scc1 L_bo_196
s_waitcnt vmcnt(11)
L_bo_196:
buffer_load_dwordx4 v[76:79], v1, s[44:47], s65 offen offset:3072 nt
v_perm_b32 v232, v102, v98, s57
v_perm_b32 v233, v110, v106, s57
v_perm_b32 v234, v118, v114, s57
v_perm_b32 v235, v126, v122, s57
v_mfma_f32_16x16x32_bf16 v[48:51], v[228:231], v[224:227], v[48:51]
s_add_u32 s65, s11, 2031616
s_waitcnt lgkmcnt(0)
v_cmp_eq_u32 vcc, 1, v236
v_readfirstlane_b32 s14, v236
ds_read_b32 v236, v237 offset:29468
s_waitcnt vmcnt(14)
s_cbranch_vccnz L_bo_197
s_waitcnt vmcnt(12)
s_cmp_eq_u32 s14, 3
s_cbranch_scc1 L_bo_197
s_waitcnt vmcnt(11)
L_bo_197:
buffer_load_dwordx4 v[80:83], v1, s[44:47], s65 offen offset:0 nt
v_perm_b32 v228, v103, v99, s56
v_perm_b32 v229, v111, v107, s56
v_perm_b32 v230, v119, v115, s56
v_perm_b32 v231, v127, v123, s56
v_mfma_f32_16x16x32_bf16 v[52:55], v[232:235], v[224:227], v[52:55]
s_waitcnt vmcnt(14)
s_cbranch_vccnz L_bo_198
s_waitcnt vmcnt(12)
s_cmp_eq_u32 s14, 3
s_cbranch_scc1 L_bo_198
s_waitcnt vmcnt(11)
L_bo_198:
buffer_load_dwordx4 v[84:87], v1, s[44:47], s65 offen offset:1024 nt
v_perm_b32 v232, v103, v99, s57
v_perm_b32 v233, v111, v107, s57
v_perm_b32 v234, v119, v115, s57
v_perm_b32 v235, v127, v123, s57
v_mfma_f32_16x16x32_bf16 v[56:59], v[228:231], v[224:227], v[56:59]
s_waitcnt vmcnt(14)
s_cbranch_vccnz L_bo_199
s_waitcnt vmcnt(12)
s_cmp_eq_u32 s14, 3
s_cbranch_scc1 L_bo_199
s_waitcnt vmcnt(11)
L_bo_199:
buffer_load_dwordx4 v[88:91], v1, s[44:47], s65 offen offset:2048 nt
s_nop 1
v_mfma_f32_16x16x32_bf16 v[60:63], v[232:235], v[224:227], v[60:63]
s_waitcnt vmcnt(14)
s_cbranch_vccnz L_bo_200
s_waitcnt vmcnt(12)
s_cmp_eq_u32 s14, 3
s_cbranch_scc1 L_bo_200
s_waitcnt vmcnt(11)
L_bo_200:
buffer_load_dwordx4 v[92:95], v1, s[44:47], s65 offen offset:3072 nt
v_mov_b32 v30, 32
ds_write_b32 v3, v30 offset:28416
s_waitcnt vmcnt(8)
v_mov_b32 v224, v29
v_mov_b32_dpp v225, v29 row_ror:12 row_mask:0xf bank_mask:0xf
v_mov_b32_dpp v226, v29 row_ror:8 row_mask:0xf bank_mask:0xf
v_mov_b32_dpp v227, v29 row_ror:4 row_mask:0xf bank_mask:0xf
v_perm_b32 v228, v132, v128, s56
v_perm_b32 v229, v140, v136, s56
v_perm_b32 v230, v148, v144, s56
v_perm_b32 v231, v156, v152, s56
v_perm_b32 v232, v132, v128, s57
v_perm_b32 v233, v140, v136, s57
v_perm_b32 v234, v148, v144, s57
v_perm_b32 v235, v156, v152, s57
v_mfma_f32_16x16x32_bf16 v[32:35], v[228:231], v[224:227], v[32:35]
v_perm_b32 v228, v133, v129, s56
v_perm_b32 v229, v141, v137, s56
v_perm_b32 v230, v149, v145, s56
v_perm_b32 v231, v157, v153, s56
v_mfma_f32_16x16x32_bf16 v[36:39], v[232:235], v[224:227], v[36:39]
v_perm_b32 v232, v133, v129, s57
v_perm_b32 v233, v141, v137, s57
v_perm_b32 v234, v149, v145, s57
v_perm_b32 v235, v157, v153, s57
v_mfma_f32_16x16x32_bf16 v[40:43], v[228:231], v[224:227], v[40:43]
v_perm_b32 v228, v134, v130, s56
v_perm_b32 v229, v142, v138, s56
v_perm_b32 v230, v150, v146, s56
v_perm_b32 v231, v158, v154, s56
v_mfma_f32_16x16x32_bf16 v[44:47], v[232:235], v[224:227], v[44:47]
v_perm_b32 v232, v134, v130, s57
v_perm_b32 v233, v142, v138, s57
v_perm_b32 v234, v150, v146, s57
v_perm_b32 v235, v158, v154, s57
v_mfma_f32_16x16x32_bf16 v[48:51], v[228:231], v[224:227], v[48:51]
v_perm_b32 v228, v135, v131, s56
v_perm_b32 v229, v143, v139, s56
v_perm_b32 v230, v151, v147, s56
v_perm_b32 v231, v159, v155, s56
v_mfma_f32_16x16x32_bf16 v[52:55], v[232:235], v[224:227], v[52:55]
v_perm_b32 v232, v135, v131, s57
v_perm_b32 v233, v143, v139, s57
v_perm_b32 v234, v151, v147, s57
v_perm_b32 v235, v159, v155, s57
v_mfma_f32_16x16x32_bf16 v[56:59], v[228:231], v[224:227], v[56:59]
s_nop 1
v_mfma_f32_16x16x32_bf16 v[60:63], v[232:235], v[224:227], v[60:63]
s_waitcnt vmcnt(0)
v_mov_b32 v224, v238
v_mov_b32_dpp v225, v238 row_ror:12 row_mask:0xf bank_mask:0xf
v_mov_b32_dpp v226, v238 row_ror:8 row_mask:0xf bank_mask:0xf
v_mov_b32_dpp v227, v238 row_ror:4 row_mask:0xf bank_mask:0xf
v_perm_b32 v228, v68, v64, s56
v_perm_b32 v229, v76, v72, s56
v_perm_b32 v230, v84, v80, s56
v_perm_b32 v231, v92, v88, s56
v_perm_b32 v232, v68, v64, s57
v_perm_b32 v233, v76, v72, s57
v_perm_b32 v234, v84, v80, s57
v_perm_b32 v235, v92, v88, s57
v_mfma_f32_16x16x32_bf16 v[32:35], v[228:231], v[224:227], v[32:35]
v_perm_b32 v228, v69, v65, s56
v_perm_b32 v229, v77, v73, s56
v_perm_b32 v230, v85, v81, s56
v_perm_b32 v231, v93, v89, s56
v_mfma_f32_16x16x32_bf16 v[36:39], v[232:235], v[224:227], v[36:39]
v_perm_b32 v232, v69, v65, s57
v_perm_b32 v233, v77, v73, s57
v_perm_b32 v234, v85, v81, s57
v_perm_b32 v235, v93, v89, s57
v_mfma_f32_16x16x32_bf16 v[40:43], v[228:231], v[224:227], v[40:43]
s_mov_b64 exec, s[68:69]
ds_write_b128 v0, v[32:35] offset:19968
s_mov_b64 exec, -1
v_perm_b32 v228, v70, v66, s56
v_perm_b32 v229, v78, v74, s56
v_perm_b32 v230, v86, v82, s56
v_perm_b32 v231, v94, v90, s56
v_mfma_f32_16x16x32_bf16 v[44:47], v[232:235], v[224:227], v[44:47]
s_mov_b64 exec, s[68:69]
ds_write_b128 v0, v[36:39] offset:20032
s_mov_b64 exec, -1
v_perm_b32 v232, v70, v66, s57
v_perm_b32 v233, v78, v74, s57
v_perm_b32 v234, v86, v82, s57
v_perm_b32 v235, v94, v90, s57
v_mfma_f32_16x16x32_bf16 v[48:51], v[228:231], v[224:227], v[48:51]
s_mov_b64 exec, s[68:69]
ds_write_b128 v0, v[40:43] offset:20096
s_mov_b64 exec, -1
v_perm_b32 v228, v71, v67, s56
v_perm_b32 v229, v79, v75, s56
v_perm_b32 v230, v87, v83, s56
v_perm_b32 v231, v95, v91, s56
v_mfma_f32_16x16x32_bf16 v[52:55], v[232:235], v[224:227], v[52:55]
s_mov_b64 exec, s[68:69]
ds_write_b128 v0, v[44:47] offset:20160
s_mov_b64 exec, -1
v_perm_b32 v232, v71, v67, s57
v_perm_b32 v233, v79, v75, s57
v_perm_b32 v234, v87, v83, s57
v_perm_b32 v235, v95, v91, s57
v_mfma_f32_16x16x32_bf16 v[56:59], v[228:231], v[224:227], v[56:59]
s_mov_b64 exec, s[68:69]
ds_write_b128 v0, v[48:51] offset:20224
s_mov_b64 exec, -1
s_nop 1
v_mfma_f32_16x16x32_bf16 v[60:63], v[232:235], v[224:227], v[60:63]
s_mov_b64 exec, s[68:69]
ds_write_b128 v0, v[52:55] offset:20288
s_mov_b64 exec, -1
L_sdone:
s_mov_b32 exec_lo, 0x000f000f
s_mov_b32 exec_hi, 0x000f000f
ds_write_b128 v0, v[56:59] offset:20352
s_nop 1
ds_write_b128 v0, v[60:63] offset:20416
s_waitcnt lgkmcnt(0)
s_barrier
s_endpgm
L_service:
s_setprio 3
s_sub_u32 s53, s52, 4
s_lshl_b32 s66, s53, 12
s_mov_b32 s3, 524288
s_lshr_b32 s68, s49, 3
s_and_b32 s69, s49, 7
v_lshrrev_b32 v2, 5, v0
s_lshl_b32 s54, s53, 1
v_add_u32 v2, s54, v2
v_and_b32 v3, 31, v0
v_lshlrev_b32 v3, 4, v3
v_lshl_add_u32 v4, v2, 10, v3
s_xor_b32 s13, s2, s49
s_and_b32 s13, s13, 1
s_lshr_b32 s14, s49, 4
s_bfe_u32 s15, s49, 0x30001
s_lshl_b32 s54, s53, 7
v_lshrrev_b32 v14, 2, v0
v_add_u32 v6, s54, v14
v_lshlrev_b32 v6, 13, v6
v_and_b32 v13, 0x30, v1
s_lshr_b32 s55, s49, 1
s_lshl_b32 s55, s55, 6
s_lshl_b32 s54, s48, 10
s_add_u32 s54, s54, s55
v_add3_u32 v6, v6, v13, s54
s_lshl_b32 s54, s48, 13
s_add_u32 s54, s54, s55
v_lshlrev_b32 v14, 10, v14
v_add3_u32 v14, v14, v13, s54
v_and_b32 v7, 7, v0
v_and_b32 v15, 0x30, v0
v_lshlrev_b32 v77, 2, v7
s_and_b32 s14, s15, 1
s_lshl_b32 s14, s14, 2
v_mov_b32 v40, -1
v_mov_b32 v41, -1
v_mov_b32 v42, -1
v_mov_b32 v43, -1
s_lshl_b32 s71, s53, 13
s_add_u32 m0, s71, 30720
v_lshrrev_b32 v44, 1, v0
v_lshlrev_b32 v44, 9, v44
v_and_b32 v45, 16, v1
v_add3_u32 v79, v44, v45, s3
v_mov_b32 v44, 0
v_mov_b32 v45, 0
v_mov_b32 v46, 0
v_mov_b32 v47, 0
v_mov_b32 v11, 0
v_mov_b32 v12, 1
s_lshl_b32 s12, s2, 2
s_add_u32 s12, s12, s53
s_waitcnt lgkmcnt(0)
s_cmp_lg_u32 s13, 0
s_cbranch_scc1 L_clr
global_load_dwordx4 v[32:35], v4, s[16:17]
global_load_dwordx4 v[36:39], v4, s[16:17] offset:512
s_xor_b32 s54, s14, 0
s_lshl_b32 s55, s54, 17
v_add_u32 v13, s55, v6
s_lshl_b32 s54, s54, 10
s_add_u32 s54, s54, s71
s_add_u32 m0, s54, 30720
s_nop 0
global_load_lds_dwordx4 v13, s[22:23]
s_xor_b32 s54, s14, 1
s_lshl_b32 s55, s54, 17
v_add_u32 v13, s55, v6
s_lshl_b32 s54, s54, 10
s_add_u32 s54, s54, s71
s_add_u32 m0, s54, 30720
s_nop 0
global_load_lds_dwordx4 v13, s[22:23]
s_xor_b32 s54, s14, 2
s_lshl_b32 s55, s54, 17
v_add_u32 v13, s55, v6
s_lshl_b32 s54, s54, 10
s_add_u32 s54, s54, s71
s_add_u32 m0, s54, 30720
s_nop 0
global_load_lds_dwordx4 v13, s[22:23]
s_xor_b32 s54, s14, 3
s_lshl_b32 s55, s54, 17
v_add_u32 v13, s55, v6
s_lshl_b32 s54, s54, 10
s_add_u32 s54, s54, s71
s_add_u32 m0, s54, 30720
s_nop 0
global_load_lds_dwordx4 v13, s[22:23]
s_xor_b32 s54, s14, 4
s_lshl_b32 s55, s54, 17
v_add_u32 v13, s55, v6
s_lshl_b32 s54, s54, 10
s_add_u32 s54, s54, s71
s_add_u32 m0, s54, 30720
s_nop 0
global_load_lds_dwordx4 v13, s[22:23]
s_xor_b32 s54, s14, 5
s_lshl_b32 s55, s54, 17
v_add_u32 v13, s55, v6
s_lshl_b32 s54, s54, 10
s_add_u32 s54, s54, s71
s_add_u32 m0, s54, 30720
s_nop 0
global_load_lds_dwordx4 v13, s[22:23]
s_xor_b32 s54, s14, 6
s_lshl_b32 s55, s54, 17
v_add_u32 v13, s55, v6
s_lshl_b32 s54, s54, 10
s_add_u32 s54, s54, s71
s_add_u32 m0, s54, 30720
s_nop 0
global_load_lds_dwordx4 v13, s[22:23]
s_xor_b32 s54, s14, 7
s_lshl_b32 s55, s54, 17
v_add_u32 v13, s55, v6
s_lshl_b32 s54, s54, 10
s_add_u32 s54, s54, s71
s_add_u32 m0, s54, 30720
s_nop 0
global_load_lds_dwordx4 v13, s[22:23]
s_branch L_clrd
L_clr:
s_cmp_lg_u32 s53, 3
s_cbranch_scc1 L_nolead
s_cmp_ge_u32 s49, 2
s_cbranch_scc1 L_nolead
s_lshl_b32 s54, s48, 13
s_add_u32 s54, s54, 4096
v_add_u32 v48, s54, v1
s_lshl_b32 s54, s48, 11
v_add_u32 v49, s54, v79
s_lshl_b32 s54, s48, 2
v_mov_b32 v52, s54
global_store_dwordx4 v48, v[40:43], s[38:39] offset:-4096 sc1
global_store_dwordx4 v48, v[40:43], s[38:39] offset:-3072 sc1
global_store_dwordx4 v48, v[40:43], s[38:39] offset:-2048 sc1
global_store_dwordx4 v48, v[40:43], s[38:39] offset:-1024 sc1
global_store_dwordx4 v48, v[40:43], s[38:39] offset:0 sc1
global_store_dwordx4 v48, v[40:43], s[38:39] offset:1024 sc1
global_store_dwordx4 v48, v[40:43], s[38:39] offset:2048 sc1
global_store_dwordx4 v48, v[40:43], s[38:39] offset:3072 sc1
s_mov_b64 exec, 0xff
global_store_dwordx4 v49, v[44:47], s[38:39] sc1
global_store_dwordx4 v49, v[44:47], s[38:39] offset:256 sc1
s_waitcnt vmcnt(0)
s_mov_b64 exec, 1
global_store_dword v52, v12, s[36:37] sc1
s_mov_b64 exec, -1
L_nolead:
s_lshr_b32 s54, s2, 1
s_lshl_b32 s54, s54, 2
s_add_u32 s54, s54, s53
s_mul_i32 s54, s54, 3584
s_add_u32 s54, s54, 2097152
v_add_u32 v6, s54, v1
global_store_dwordx4 v6, v[40:43], s[38:39] offset:0 sc1
global_store_dwordx4 v6, v[40:43], s[38:39] offset:1024 sc1
global_store_dwordx4 v6, v[40:43], s[38:39] offset:2048 sc1
s_mov_b32 exec_hi, 0
global_store_dwordx4 v6, v[40:43], s[38:39] offset:3072 sc1
s_mov_b64 exec, -1
s_lshl_b32 s54, s48, 2
s_add_u32 s54, s54, s68
s_lshl_b32 s54, s54, 7
s_lshl_b32 s55, s53, 1
s_add_u32 s54, s54, s55
s_lshl_b32 s54, s54, 10
s_and_b32 s55, s15, 3
s_lshl_b32 s55, s55, 8
s_add_u32 s54, s54, s55
v_lshrrev_b32 v48, 4, v0
v_lshlrev_b32 v48, 13, v48
v_and_b32 v49, 15, v0
v_lshl_add_u32 v48, v49, 4, v48
v_add_u32 v48, s54, v48
v_add_u32 v49, 0, v48
s_add_u32 m0, s71, 30720
s_nop 0
global_load_lds_dwordx4 v49, s[24:25] nt
v_add_u32 v49, 32768, v48
s_add_u32 m0, s71, 31744
s_nop 0
global_load_lds_dwordx4 v49, s[24:25] nt
v_add_u32 v49, 65536, v48
s_add_u32 m0, s71, 32768
s_nop 0
global_load_lds_dwordx4 v49, s[24:25] nt
v_add_u32 v49, 98304, v48
s_add_u32 m0, s71, 33792
s_nop 0
global_load_lds_dwordx4 v49, s[24:25] nt
v_add_u32 v49, 1024, v48
s_add_u32 m0, s71, 34816
s_nop 0
global_load_lds_dwordx4 v49, s[24:25] nt
v_add_u32 v49, 33792, v48
s_add_u32 m0, s71, 35840
s_nop 0
global_load_lds_dwordx4 v49, s[24:25] nt
v_add_u32 v49, 66560, v48
s_add_u32 m0, s71, 36864
s_nop 0
global_load_lds_dwordx4 v49, s[24:25] nt
v_add_u32 v49, 99328, v48
s_add_u32 m0, s71, 37888
s_nop 0
global_load_lds_dwordx4 v49, s[24:25] nt
L_clrd:
s_mov_b64 exec, -1
s_and_b32 s54, s49, 3
s_lshl_b32 s9, s54, 16
s_lshr_b32 s54, s49, 2
s_lshl_b32 s54, s54, 10
s_add_u32 s9, s9, s54
s_lshl_b32 s54, s48, 7
s_add_u32 s9, s9, s54
s_add_u32 s9, s9, 3932160
s_lshl_b32 s54, s53, 14
s_add_u32 s54, s54, s9
v_bfe_u32 v6, v0, 3, 1
v_lshlrev_b32 v6, 13, v6
v_and_b32 v13, 0x70, v1
v_add3_u32 v6, v6, v13, s54
s_mov_b64 exec, 0xffff
s_cmp_ge_u32 s49, 4
s_cbranch_scc1 L_nopl
s_cmp_ge_u32 s53, 3
s_cbranch_scc1 L_nopl
global_store_dwordx4 v6, v[40:43], s[38:39] sc1
L_nopl:
s_mov_b64 exec, -1
v_mul_u32_u24 v5, 1040, v2
v_add_u32 v5, v5, v3
v_lshrrev_b32 v8, 4, v0
v_lshlrev_b32 v8, 9, v8
v_bfe_u32 v9, v0, 2, 2
v_lshl_add_u32 v8, v9, 6, v8
v_and_b32 v9, 3, v0
v_lshl_add_u32 v8, v9, 3, v8
v_add_u32 v8, s71, v8
v_mul_u32_u24 v9, 1040, v7
v_add_u32 v9, v9, v15
s_lshl_b32 s54, s53, 8
v_add_u32 v10, s54, v9
s_lshl_b32 s54, s53, 8
v_mov_b32 v31, s54
v_mov_b32 v76, 0
s_cmp_lg_u32 s13, 0
s_cbranch_scc1 L_noln
s_waitcnt vmcnt(8)
v_lshlrev_b32 v48, 16, v32
v_and_b32 v49, s60, v32
v_lshlrev_b32 v50, 16, v33
v_and_b32 v51, s60, v33
v_lshlrev_b32 v52, 16, v34
v_and_b32 v53, s60, v34
v_lshlrev_b32 v54, 16, v35
v_and_b32 v55, s60, v35
v_lshlrev_b32 v56, 16, v36
v_and_b32 v57, s60, v36
v_lshlrev_b32 v58, 16, v37
v_and_b32 v59, s60, v37
v_lshlrev_b32 v60, 16, v38
v_and_b32 v61, s60, v38
v_lshlrev_b32 v62, 16, v39
v_and_b32 v63, s60, v39
v_pk_add_f32 v[64:65], v[48:49], v[50:51]
v_pk_mul_f32 v[66:67], v[48:49], v[48:49]
v_pk_add_f32 v[68:69], v[52:53], v[54:55]
v_pk_mul_f32 v[70:71], v[50:51], v[50:51]
v_pk_fma_f32 v[66:67], v[52:53], v[52:53], v[66:67]
v_pk_fma_f32 v[70:71], v[54:55], v[54:55], v[70:71]
v_pk_add_f32 v[64:65], v[64:65], v[56:57]
v_pk_fma_f32 v[66:67], v[56:57], v[56:57], v[66:67]
v_pk_add_f32 v[68:69], v[68:69], v[58:59]
v_pk_fma_f32 v[70:71], v[58:59], v[58:59], v[70:71]
v_pk_add_f32 v[64:65], v[64:65], v[60:61]
v_pk_fma_f32 v[66:67], v[60:61], v[60:61], v[66:67]
v_pk_add_f32 v[68:69], v[68:69], v[62:63]
v_pk_fma_f32 v[70:71], v[62:63], v[62:63], v[70:71]
v_pk_add_f32 v[64:65], v[64:65], v[68:69]
v_pk_add_f32 v[66:67], v[66:67], v[70:71]
v_add_f32 v64, v64, v65
v_add_f32 v66, v66, v67
s_nop 0
v_add_f32_dpp v64, v64, v64 row_ror:1 row_mask:0xf bank_mask:0xf
v_add_f32_dpp v66, v66, v66 row_ror:1 row_mask:0xf bank_mask:0xf
s_nop 0
v_add_f32_dpp v64, v64, v64 row_ror:2 row_mask:0xf bank_mask:0xf
v_add_f32_dpp v66, v66, v66 row_ror:2 row_mask:0xf bank_mask:0xf
s_nop 0
v_add_f32_dpp v64, v64, v64 row_ror:4 row_mask:0xf bank_mask:0xf
v_add_f32_dpp v66, v66, v66 row_ror:4 row_mask:0xf bank_mask:0xf
s_nop 0
v_add_f32_dpp v64, v64, v64 row_ror:8 row_mask:0xf bank_mask:0xf
v_add_f32_dpp v66, v66, v66 row_ror:8 row_mask:0xf bank_mask:0xf
v_mov_b32 v65, v64
v_mov_b32 v67, v66
s_nop 0
v_permlane16_swap_b32 v64, v65
v_permlane16_swap_b32 v66, v67
v_add_f32 v64, v64, v65
v_add_f32 v66, v66, v67
v_mul_f32 v64, 0xbb000000, v64
v_mul_f32 v66, 0x3b000000, v66
v_cvt_pk_bf16_f32 v68, 0, v64
v_fma_f32 v66, -v64, v64, v66
v_pk_add_f32 v[48:49], v[48:49], v[68:69] op_sel_hi:[1,0]
v_max_f32 v66, 0, v66
v_pk_add_f32 v[50:51], v[50:51], v[68:69] op_sel_hi:[1,0]
v_cvt_pk_bf16_f32 v66, 0, v66
v_pk_add_f32 v[52:53], v[52:53], v[68:69] op_sel_hi:[1,0]
v_add_f32 v66, 0x3727c5ac, v66
v_pk_add_f32 v[54:55], v[54:55], v[68:69] op_sel_hi:[1,0]
v_cvt_pk_bf16_f32 v66, 0, v66
v_pk_add_f32 v[56:57], v[56:57], v[68:69] op_sel_hi:[1,0]
v_sqrt_f32 v66, v66
v_pk_add_f32 v[58:59], v[58:59], v[68:69] op_sel_hi:[1,0]
v_cvt_pk_bf16_f32 v66, 0, v66
v_pk_add_f32 v[60:61], v[60:61], v[68:69] op_sel_hi:[1,0]
v_rcp_f32 v66, v66
v_pk_add_f32 v[62:63], v[62:63], v[68:69] op_sel_hi:[1,0]
v_cvt_pk_bf16_f32 v48, 0, v48
v_cvt_pk_bf16_f32 v49, 0, v49
v_cvt_pk_bf16_f32 v50, 0, v50
v_cvt_pk_bf16_f32 v51, 0, v51
v_cvt_pk_bf16_f32 v52, 0, v52
v_cvt_pk_bf16_f32 v53, 0, v53
v_cvt_pk_bf16_f32 v54, 0, v54
v_cvt_pk_bf16_f32 v55, 0, v55
v_cvt_pk_bf16_f32 v56, 0, v56
v_cvt_pk_bf16_f32 v57, 0, v57
v_cvt_pk_bf16_f32 v58, 0, v58
v_cvt_pk_bf16_f32 v59, 0, v59
v_cvt_pk_bf16_f32 v60, 0, v60
v_cvt_pk_bf16_f32 v61, 0, v61
v_cvt_pk_bf16_f32 v62, 0, v62
v_cvt_pk_bf16_f32 v63, 0, v63
v_pk_mul_f32 v[48:49], v[48:49], v[66:67] op_sel_hi:[1,0]
v_pk_mul_f32 v[50:51], v[50:51], v[66:67] op_sel_hi:[1,0]
v_pk_mul_f32 v[52:53], v[52:53], v[66:67] op_sel_hi:[1,0]
v_pk_mul_f32 v[54:55], v[54:55], v[66:67] op_sel_hi:[1,0]
v_pk_mul_f32 v[56:57], v[56:57], v[66:67] op_sel_hi:[1,0]
v_pk_mul_f32 v[58:59], v[58:59], v[66:67] op_sel_hi:[1,0]
v_pk_mul_f32 v[60:61], v[60:61], v[66:67] op_sel_hi:[1,0]
v_pk_mul_f32 v[62:63], v[62:63], v[66:67] op_sel_hi:[1,0]
v_cvt_pk_bf16_f32 v32, v48, v49
v_cvt_pk_bf16_f32 v33, v50, v51
v_cvt_pk_bf16_f32 v34, v52, v53
v_cvt_pk_bf16_f32 v35, v54, v55
ds_write_b128 v5, v[32:35] offset:1280
v_cvt_pk_bf16_f32 v36, v56, v57
v_cvt_pk_bf16_f32 v37, v58, v59
v_cvt_pk_bf16_f32 v38, v60, v61
v_cvt_pk_bf16_f32 v39, v62, v63
ds_write_b128 v5, v[36:39] offset:1792
L_noln:
s_waitcnt vmcnt(0)
s_waitcnt lgkmcnt(0)
s_mov_b64 exec, 1
ds_add_u32 v11, v12 offset:29440
s_mov_b64 exec, -1
s_mov_b32 s58, 2097152
L_lw_217:
ds_read_b32 v13, v11 offset:29440
s_waitcnt lgkmcnt(0)
v_readfirstlane_b32 s54, v13
s_cmp_ge_u32 s54, 4
s_cbranch_scc1 L_ld_218
s_sub_u32 s58, s58, 1
s_cmp_lg_u32 s58, 0
s_cbranch_scc1 L_lw_217
L_ld_218:
s_lshl_b32 s54, s48, 2
s_add_u32 s54, s54, s68
s_lshl_b32 s54, s54, 9
s_lshl_b32 s55, s69, 2
s_add_u32 s54, s54, s55
s_add_u32 s54, s54, s3
v_mov_b32 v6, s54
s_getreg_b32 s10, hwreg(HW_REG_XCC_ID)
s_and_b32 s65, s10, 15
s_bfe_u32 s10, s10, 0x10002
s_lshl_b32 s65, s65, 4
s_lshl_b32 s54, s10, 2
s_or_b32 s65, s65, s54
s_or_b32 s65, s65, 1
s_cmp_lg_u32 s53, 3
s_cbranch_scc1 L_noflag
s_mov_b64 exec, 0xff
global_load_dword v76, v77, s[36:37] sc1
s_mov_b64 exec, -1
s_cmp_eq_u32 s13, 0
s_cbranch_scc1 L_noflag
s_mov_b64 exec, 0xff
s_waitcnt vmcnt(0)
v_cmp_eq_u32 vcc, 0, v76
s_cbranch_vccz L_godr
s_mov_b32 s61, 131072
L_gor:
s_sleep 8
global_load_dword v13, v77, s[36:37] sc1
s_waitcnt vmcnt(0)
v_cmp_eq_u32 vcc, 0, v13
s_cbranch_vccz L_godr
s_sub_u32 s61, s61, 1
s_cmp_lg_u32 s61, 0
s_cbranch_scc1 L_gor
L_godr:
s_mov_b64 exec, 1
v_mov_b32 v7, s65
global_store_dword v6, v7, s[38:39] sc1
s_mov_b64 exec, -1
L_noflag:
s_cmp_lg_u32 s13, 0
s_cbranch_scc1 L_noq
ds_read_b64_tr_b16 v[80:81], v8 offset:30720
ds_read_b64_tr_b16 v[82:83], v8 offset:30976
ds_read_b128 v[112:115], v10 offset:1280
ds_read_b64_tr_b16 v[84:85], v8 offset:32768
ds_read_b64_tr_b16 v[86:87], v8 offset:33024
ds_read_b128 v[116:119], v10 offset:1344
ds_read_b64_tr_b16 v[88:89], v8 offset:34816
ds_read_b64_tr_b16 v[90:91], v8 offset:35072
ds_read_b128 v[120:123], v10 offset:1408
ds_read_b64_tr_b16 v[92:93], v8 offset:36864
ds_read_b64_tr_b16 v[94:95], v8 offset:37120
ds_read_b128 v[124:127], v10 offset:1472
s_waitcnt lgkmcnt(0)
ds_read_b64_tr_b16 v[96:97], v8 offset:30752
ds_read_b64_tr_b16 v[98:99], v8 offset:31008
ds_read_b64_tr_b16 v[100:101], v8 offset:32800
ds_read_b64_tr_b16 v[102:103], v8 offset:33056
ds_read_b64_tr_b16 v[104:105], v8 offset:34848
ds_read_b64_tr_b16 v[106:107], v8 offset:35104
ds_read_b64_tr_b16 v[108:109], v8 offset:36896
ds_read_b64_tr_b16 v[110:111], v8 offset:37152
s_waitcnt lgkmcnt(0)
v_mfma_f32_16x16x32_bf16 v[48:51], v[80:83], v[112:115], 0
v_mfma_f32_16x16x32_bf16 v[52:55], v[96:99], v[112:115], 0
v_mfma_f32_16x16x32_bf16 v[48:51], v[84:87], v[116:119], v[48:51]
v_mfma_f32_16x16x32_bf16 v[52:55], v[100:103], v[116:119], v[52:55]
v_mfma_f32_16x16x32_bf16 v[48:51], v[88:91], v[120:123], v[48:51]
v_mfma_f32_16x16x32_bf16 v[52:55], v[104:107], v[120:123], v[52:55]
v_mfma_f32_16x16x32_bf16 v[48:51], v[92:95], v[124:127], v[48:51]
v_mfma_f32_16x16x32_bf16 v[52:55], v[108:111], v[124:127], v[52:55]
s_lshl_b32 s54, s53, 11
v_add_u32 v56, s54, v1
v_and_b32 v57, 3, v0
v_lshlrev_b32 v57, 9, v57
v_bfe_u32 v58, v0, 2, 3
v_lshl_add_u32 v57, v58, 4, v57
s_nop 1
ds_write_b128 v56, v[48:51] offset:11776
ds_write_b128 v56, v[52:55] offset:12800
s_waitcnt lgkmcnt(0)
s_mov_b64 exec, 1
ds_add_u32 v11, v12 offset:29472
s_mov_b64 exec, -1
s_mov_b32 s58, 2097152
L_lw_220:
ds_read_b32 v13, v11 offset:29472
s_waitcnt lgkmcnt(0)
v_readfirstlane_b32 s54, v13
s_cmp_ge_u32 s54, 4
s_cbranch_scc1 L_ld_221
s_sub_u32 s58, s58, 1
s_cmp_lg_u32 s58, 0
s_cbranch_scc1 L_lw_220
L_ld_221:
s_cmp_lg_u32 s53, 3
s_cbranch_scc1 L_noq
ds_read_b128 v[80:83], v57 offset:11776
ds_read_b128 v[84:87], v57 offset:12032
ds_read_b128 v[88:91], v57 offset:13824
ds_read_b128 v[92:95], v57 offset:14080
ds_read_b128 v[96:99], v57 offset:15872
ds_read_b128 v[100:103], v57 offset:16128
ds_read_b128 v[104:107], v57 offset:17920
ds_read_b128 v[108:111], v57 offset:18176
s_waitcnt lgkmcnt(0)
v_pk_add_f32 v[80:81], v[80:81], v[88:89]
v_pk_add_f32 v[96:97], v[96:97], v[104:105]
v_pk_add_f32 v[82:83], v[82:83], v[90:91]
v_pk_add_f32 v[98:99], v[98:99], v[106:107]
v_pk_add_f32 v[84:85], v[84:85], v[92:93]
v_pk_add_f32 v[100:101], v[100:101], v[108:109]
v_pk_add_f32 v[86:87], v[86:87], v[94:95]
v_pk_add_f32 v[102:103], v[102:103], v[110:111]
v_pk_add_f32 v[80:81], v[80:81], v[96:97]
v_pk_add_f32 v[82:83], v[82:83], v[98:99]
v_pk_add_f32 v[84:85], v[84:85], v[100:101]
v_pk_add_f32 v[86:87], v[86:87], v[102:103]
v_cvt_pk_bf16_f32 v48, v80, v81
v_min_u32 v48, -2, v48
v_cvt_pk_bf16_f32 v49, v82, v83
v_min_u32 v49, -2, v49
v_cvt_pk_bf16_f32 v50, v84, v85
v_min_u32 v50, -2, v50
v_cvt_pk_bf16_f32 v51, v86, v87
v_min_u32 v51, -2, v51
s_mov_b64 exec, 0xff
s_waitcnt vmcnt(0)
v_cmp_eq_u32 vcc, 0, v76
s_cbranch_vccz L_godp
s_mov_b32 s61, 131072
L_gop:
s_sleep 8
global_load_dword v13, v77, s[36:37] sc1
s_waitcnt vmcnt(0)
v_cmp_eq_u32 vcc, 0, v13
s_cbranch_vccz L_godp
s_sub_u32 s61, s61, 1
s_cmp_lg_u32 s61, 0
s_cbranch_scc1 L_gop
L_godp:
s_mov_b32 exec_lo, -1
global_store_dwordx4 v14, v[48:51], s[38:39] sc1
s_mov_b64 exec, -1
L_noq:
s_mov_b64 exec, 1
ds_add_u32 v11, v12 offset:29452
s_mov_b64 exec, -1
s_cmp_eq_u32 s53, 0
s_cbranch_scc1 L_qg
s_cmp_lg_u32 s53, 1
s_cbranch_scc1 L_qdone
s_cmp_ge_u32 s49, 4
s_cbranch_scc1 L_qdone
s_mov_b32 s6, 0
s_add_u32 s7, s9, 0
s_mov_b32 s8, 0
s_mov_b32 s61, 0
s_load_dword s8, s[38:39], s7
L_pb_222:
s_add_u32 s61, s61, 1
s_cmp_gt_u32 s61, 0xffff
s_cbranch_scc1 L_pe_223
s_cmp_eq_u32 s8, 0
s_cbranch_scc1 L_pb_222
L_pe_223:
s_waitcnt lgkmcnt(0)
s_add_u32 s7, s9, 8192
s_mov_b32 s8, 0
s_mov_b32 s61, 0
s_load_dword s8, s[38:39], s7
L_pb_224:
s_add_u32 s61, s61, 1
s_cmp_gt_u32 s61, 0xffff
s_cbranch_scc1 L_pe_225
s_cmp_eq_u32 s8, 0
s_cbranch_scc1 L_pb_224
L_pe_225:
s_waitcnt lgkmcnt(0)
s_add_u32 s7, s9, 24576
s_mov_b32 s8, 0
s_mov_b32 s61, 0
s_load_dword s8, s[38:39], s7
L_pb_226:
s_add_u32 s61, s61, 1
s_cmp_gt_u32 s61, 0xffff
s_cbranch_scc1 L_pe_227
s_cmp_eq_u32 s8, 0
s_cbranch_scc1 L_pb_226
L_pe_227:
s_waitcnt lgkmcnt(0)
s_sub_i32 s6, s6, s61
s_add_u32 s7, s9, 16384
s_mov_b32 s8, 0
s_mov_b32 s61, 0
s_load_dword s8, s[38:39], s7
L_pb_228:
s_add_u32 s61, s61, 1
s_cmp_gt_u32 s61, 0xffff
s_cbranch_scc1 L_pe_229
s_cmp_eq_u32 s8, 0
s_cbranch_scc1 L_pb_228
L_pe_229:
s_waitcnt lgkmcnt(0)
s_add_i32 s6, s6, s61
s_add_u32 s7, s9, 32768
s_mov_b32 s8, 0
s_mov_b32 s61, 0
s_load_dword s8, s[38:39], s7
L_pb_230:
s_add_u32 s61, s61, 1
s_cmp_gt_u32 s61, 0xffff
s_cbranch_scc1 L_pe_231
s_cmp_eq_u32 s8, 0
s_cbranch_scc1 L_pb_230
L_pe_231:
s_waitcnt lgkmcnt(0)
s_add_i32 s6, s6, s61
s_add_u32 s7, s9, 40960
s_mov_b32 s8, 0
s_mov_b32 s61, 0
s_load_dword s8, s[38:39], s7
L_pb_232:
s_add_u32 s61, s61, 1
s_cmp_gt_u32 s61, 0xffff
s_cbranch_scc1 L_pe_233
s_cmp_eq_u32 s8, 0
s_cbranch_scc1 L_pb_232
L_pe_233:
s_waitcnt lgkmcnt(0)
s_sub_i32 s6, s6, s61
s_cmp_gt_i32 s6, 0
s_cselect_b32 s6, 1, 0
s_xor_b32 s6, s6, s10
s_lshl_b32 s6, s6, 1
s_or_b32 s6, s6, 1
v_mov_b32 v7, s6
s_mov_b32 s58, 2097152
L_lw_234:
ds_read_b32 v13, v11 offset:29452
s_waitcnt lgkmcnt(0)
v_readfirstlane_b32 s54, v13
s_cmp_ge_u32 s54, 4
s_cbranch_scc1 L_ld_235
s_sleep 2
s_sub_u32 s58, s58, 1
s_cmp_lg_u32 s58, 0
s_cbranch_scc1 L_lw_234
L_ld_235:
s_mov_b64 exec, 1
global_store_dword v6, v7, s[38:39] offset:256 sc1
s_mov_b64 exec, -1
s_branch L_qdone
L_qg:
v_and_b32 v6, 3, v0
v_lshlrev_b32 v6, 8, v6
v_lshrrev_b32 v14, 2, v0
v_lshl_add_u32 v6, v14, 4, v6
s_and_b32 s54, s50, 7
s_lshl_b32 s54, s54, 13
s_lshr_b32 s55, s50, 3
s_lshl_b32 s55, s55, 10
s_add_u32 s54, s54, s55
v_add_u32 v6, s54, v6
s_mov_b32 s58, 2097152
L_lw_236:
ds_read_b32 v13, v11 offset:29452
s_waitcnt lgkmcnt(0)
v_readfirstlane_b32 s54, v13
s_cmp_ge_u32 s54, 4
s_cbranch_scc1 L_ld_237
s_sleep 2
s_sub_u32 s58, s58, 1
s_cmp_lg_u32 s58, 0
s_cbranch_scc1 L_lw_236
L_ld_237:
s_mov_b32 s58, 2097152
L_lw_238:
ds_read_b32 v13, v31 offset:28416
s_waitcnt lgkmcnt(0)
v_readfirstlane_b32 s54, v13
s_cmp_ge_u32 s54, 5
s_cbranch_scc1 L_ld_239
s_sleep 6
s_sub_u32 s58, s58, 1
s_cmp_lg_u32 s58, 0
s_cbranch_scc1 L_lw_238
L_ld_239:
s_mov_b32 s61, 131072
L_pl_240:
global_load_dwordx4 v[32:35], v6, s[38:39] sc1
s_waitcnt vmcnt(0)
v_max3_u32 v13, v32, v33, v34
v_max_u32 v13, v13, v35
v_cmp_eq_u32 vcc, -1, v13
s_cbranch_vccz L_pd_241
s_sleep 8
s_sub_u32 s61, s61, 1
s_cmp_lg_u32 s61, 0
s_cbranch_scc1 L_pl_240
L_pd_241:
ds_write_b128 v1, v[32:35] offset:256
s_waitcnt lgkmcnt(0)
ds_write_b32 v11, v12 offset:29456
L_qdone:
s_lshl_b32 s54, s50, 21
s_load_dword s4, s[20:21], s54
s_load_dword s6, s[28:29], 0
s_load_dword s7, s[30:31], 0
s_load_dword s8, s[32:33], 0
s_lshl_b32 s54, s48, 19
s_load_dword s9, s[24:25], s54
s_waitcnt lgkmcnt(0)
s_setprio 0
s_mov_b32 s70, 0
s_and_b32 s54, s49, 0x13
s_cmp_eq_u32 s54, s64
s_cselect_b32 s70, 2, s70
s_cmp_lt_u32 s48, 4
s_cselect_b32 s6, 16, 12
s_cselect_b32 s7, 8, 6
s_cselect_b32 s8, 0, 8
s_mul_i32 s14, s48, s7
s_add_u32 s14, s14, s8
s_and_b32 s54, s49, 0x13
s_xor_b32 s54, s54, 2
s_cmp_eq_u32 s54, s64
s_cselect_b32 s9, s49, 99
s_cmp_lt_u32 s9, s6
s_cselect_b32 s70, 4, s70
s_sub_u32 s54, s49, 16
s_cmp_lt_u32 s54, s6
s_cselect_b32 s70, 1, s70
s_xor_b32 s55, s2, s49
s_and_b32 s55, s55, 1
s_cselect_b32 s70, 3, s70
s_bfe_u32 s54, s49, 0x30001
s_add_u32 s14, s14, s54
s_lshr_b32 s15, s49, 2
s_add_u32 s54, s48, 0
s_and_b32 s54, s54, 7
s_lshl_b32 s54, s54, 2
s_add_u32 s15, s15, s54
s_cmp_lg_u32 s70, 1
s_cbranch_scc1 L_ne1
s_mov_b32 s58, 2097152
L_lw_242:
ds_read_b32 v13, v11 offset:29452
s_waitcnt lgkmcnt(0)
v_readfirstlane_b32 s54, v13
s_cmp_ge_u32 s54, 4
s_cbranch_scc1 L_ld_243
s_sleep 2
s_sub_u32 s58, s58, 1
s_cmp_lg_u32 s58, 0
s_cbranch_scc1 L_lw_242
L_ld_243:
s_lshl_b32 s54, s14, 6
s_lshl_b32 s55, s53, 7
v_lshrrev_b32 v6, 2, v0
v_add_u32 v6, s55, v6
v_mul_u32_u24 v6, 3584, v6
v_and_b32 v7, 3, v0
v_lshl_add_u32 v6, v7, 4, v6
v_add_u32 v6, s54, v6
v_add_u32 v7, 0, v6
s_add_u32 m0, s71, 30720
s_nop 0
global_load_lds_dwordx4 v7, s[28:29]
v_add_u32 v7, 0, v6
s_add_u32 m0, s71, 63488
s_nop 0
global_load_lds_dwordx4 v7, s[30:31]
L_ne1:
s_cmp_lg_u32 s53, 0
s_cbranch_scc1 L_nofc
s_mov_b32 s58, 2097152
L_lw_244:
ds_read_b32 v13, v31 offset:28416
s_waitcnt lgkmcnt(0)
v_readfirstlane_b32 s54, v13
s_cmp_ge_u32 s54, 8
s_cbranch_scc1 L_ld_245
s_sleep 6
s_sub_u32 s58, s58, 1
s_cmp_lg_u32 s58, 0
s_cbranch_scc1 L_lw_244
L_ld_245:
s_mov_b32 s6, 0x00ff00ff
s_mov_b32 s7, s6
s_mov_b32 s61, 131072
s_mov_b64 exec, -1
L_fl_246:
global_load_dwordx4 v[72:75], v79, s[38:39] sc1
s_waitcnt vmcnt(0)
v_min_u32 v13, v72, v74
v_min_u32 v76, v73, v75
v_cndmask_b32 v13, v13, v76, s[6:7]
v_cmp_eq_u32 vcc, 0, v13
s_cbranch_vccz L_fd_247
s_sleep 16
s_sub_u32 s61, s61, 1
s_cmp_lg_u32 s61, 0
s_cbranch_scc1 L_fl_246
L_fd_247:
s_mov_b64 exec, -1
v_cndmask_b32 v13, v72, v73, s[6:7]
v_cndmask_b32 v76, v74, v75, s[6:7]
v_cmp_ne_u32 vcc, s65, v13
v_cmp_ne_u32 s[8:9], s65, v76
s_nop 1
s_or_b64 s[8:9], s[8:9], vcc
s_and_b32 s54, s50, 7
s_lshl_b32 s54, s54, 3
s_lshr_b64 s[8:9], s[8:9], s54
s_and_b32 s8, s8, 0xff
s_cselect_b32 s12, 0, 32
ds_write_b128 v1, v[72:75] offset:11776
v_add_u32 v7, 256, v79
s_mov_b32 s6, 0x01010101
s_mov_b32 s7, s6
s_waitcnt lgkmcnt(0)
s_mov_b32 s61, 131072
s_mov_b64 exec, s[6:7]
L_fl_248:
global_load_dwordx4 v[72:75], v7, s[38:39] sc1
s_waitcnt vmcnt(0)
v_min3_u32 v13, v72, v73, v74
v_min_u32 v13, v13, v75
v_cmp_eq_u32 vcc, 0, v13
s_cbranch_vccz L_fd_249
s_sleep 16
s_sub_u32 s61, s61, 1
s_cmp_lg_u32 s61, 0
s_cbranch_scc1 L_fl_248
L_fd_249:
s_mov_b64 exec, -1
s_and_b32 s54, s48, 3
s_lshl_b32 s54, s54, 7
s_lshl_b32 s55, s49, 2
s_add_u32 s54, s54, s55
v_mov_b32 v7, s54
s_mov_b32 s6, 0
v_and_b32 v13, 2, v72
v_cmp_ne_u32 vcc, 0, v13
s_nop 1
s_bcnt1_i32_b64 s7, vcc
s_add_u32 s6, s6, s7
v_and_b32 v13, 2, v73
v_cmp_ne_u32 vcc, 0, v13
s_nop 1
s_bcnt1_i32_b64 s7, vcc
s_add_u32 s6, s6, s7
v_and_b32 v13, 2, v74
v_cmp_ne_u32 vcc, 0, v13
s_nop 1
s_bcnt1_i32_b64 s7, vcc
s_add_u32 s6, s6, s7
v_and_b32 v13, 2, v75
v_cmp_ne_u32 vcc, 0, v13
s_nop 1
s_bcnt1_i32_b64 s7, vcc
s_add_u32 s6, s6, s7
s_waitcnt lgkmcnt(0)
ds_read_b32 v13, v7 offset:11776
s_waitcnt lgkmcnt(0)
v_readfirstlane_b32 s7, v13
s_and_b32 s54, s48, 3
s_lshl_b32 s54, s54, 7
s_andn2_b32 s55, 1, s48
s_lshl_b32 s55, s55, 2
s_add_u32 s54, s54, s55
v_mov_b32 v7, s54
s_and_b32 s54, s50, 3
s_lshl_b32 s54, s54, 7
s_andn2_b32 s55, 1, s50
s_lshl_b32 s55, s55, 2
s_add_u32 s54, s54, s55
v_mov_b32 v72, s54
ds_read_b32 v13, v7 offset:11776
ds_read_b32 v72, v72 offset:11776
s_waitcnt lgkmcnt(0)
v_readfirstlane_b32 s4, v13
v_readfirstlane_b32 s5, v72
s_xor_b32 s4, s4, s48
s_bfe_u32 s4, s4, 0x10002
s_xor_b32 s5, s5, s50
s_bfe_u32 s5, s5, 0x10002
s_cmp_ge_u32 s6, 16
s_cselect_b32 s6, 1, 0
s_xor_b32 s7, s7, s48
s_bfe_u32 s7, s7, 0x10002
s_xor_b32 s7, s7, s6
s_lshl_b32 s7, s7, 2
s_lshl_b32 s6, s6, 1
s_or_b32 s6, s6, s7
s_or_b32 s6, s6, 1
s_lshl_b32 s4, s4, 3
s_lshl_b32 s5, s5, 4
s_or_b32 s6, s6, s4
s_or_b32 s6, s6, s5
s_or_b32 s6, s6, s12
v_mov_b32 v13, s6
ds_write_b32 v11, v13 offset:29448
L_nofc:
s_mov_b32 s58, 2097152
L_lw_250:
ds_read_b32 v13, v11 offset:29448
s_waitcnt lgkmcnt(0)
v_readfirstlane_b32 s54, v13
s_cmp_ge_u32 s54, 1
s_cbranch_scc1 L_ld_251
s_sleep 6
s_sub_u32 s58, s58, 1
s_cmp_lg_u32 s58, 0
s_cbranch_scc1 L_lw_250
L_ld_251:
s_and_b32 s12, s54, 32
s_bfe_u32 s11, s54, 0x10002
s_bfe_u32 s62, s54, 0x10003
s_bfe_u32 s63, s54, 0x10004
s_bfe_u32 s54, s54, 0x10001
s_xor_b32 s10, s10, s54
s_xor_b32 s62, s62, s54
s_xor_b32 s63, s63, s54
s_lshr_b32 s13, s2, 1
s_andn2_b32 s13, s13, 2
s_lshl_b32 s54, s11, 1
s_or_b32 s13, s13, s54
s_and_b32 s54, s48, 3
s_lshl_b32 s54, s54, 2
s_add_u32 s67, s54, s68
s_lshl_b32 s54, s11, 4
s_add_u32 s67, s67, s54
s_lshl_b32 s54, s48, 2
s_add_u32 s67, s54, s68
s_bfe_u32 s69, s49, 0x20001
v_and_b32 v6, 3, v0
v_lshlrev_b32 v6, 2, v6
v_lshrrev_b32 v7, 4, v0
v_add_u32 v6, v6, v7
v_bfe_u32 v7, v0, 2, 1
v_lshrrev_b32 v24, 3, v0
v_lshlrev_b32 v24, 13, v24
v_and_b32 v13, 7, v0
v_lshl_add_u32 v24, v13, 3, v24
s_and_b32 s54, s13, 31
s_lshl_b32 s54, s54, 8
s_lshr_b32 s55, s13, 5
s_lshl_b32 s55, s55, 6
s_add_u32 s54, s54, s55
s_add_u32 s54, s54, 3407872
v_add_u32 v24, s54, v24
s_mov_b32 s55, s13
v_lshlrev_b32 v6, 1, v6
v_lshl_add_u32 v6, v7, 10, v6
s_lshr_b32 s54, s55, 5
s_lshl_b32 s54, s54, 11
s_and_b32 s55, s55, 31
s_lshl_b32 s55, s55, 5
s_add_u32 s54, s54, s55
v_add_u32 v6, s54, v6
global_load_ushort v16, v6, s[16:17]
s_cmp_eq_u32 s70, 0
s_cbranch_scc1 L_we_254
s_cmp_eq_u32 s70, 2
s_cbranch_scc1 L_w2_253
s_cmp_lg_u32 s70, 3
s_cbranch_scc1 L_w1_252
s_lshl_b32 s54, s67, 7
s_lshl_b32 s55, s53, 1
s_add_u32 s54, s54, s55
s_lshl_b32 s54, s54, 10
s_lshl_b32 s55, s69, 8
s_add_u32 s54, s54, s55
v_lshrrev_b32 v6, 4, v0
v_lshlrev_b32 v6, 13, v6
v_and_b32 v7, 15, v0
v_lshl_add_u32 v6, v7, 4, v6
v_add_u32 v6, s54, v6
s_lshl_b32 s71, s53, 13
s_branch L_we_254
L_w1_252:
s_lshl_b32 s54, s14, 6
s_lshl_b32 s55, s53, 7
v_lshrrev_b32 v6, 2, v0
v_add_u32 v6, s55, v6
v_mul_u32_u24 v6, 3584, v6
v_and_b32 v7, 3, v0
v_lshl_add_u32 v6, v7, 4, v6
v_add_u32 v6, s54, v6
s_lshl_b32 s71, s53, 13
s_cmp_eq_u32 s70, 4
s_cbranch_scc1 L_we_254
s_branch L_we_254
L_w2_253:
s_mul_i32 s54, s53, 448
v_lshrrev_b32 v6, 1, v0
v_add_u32 v6, s54, v6
v_lshlrev_b32 v6, 10, v6
v_and_b32 v7, 1, v0
v_lshl_add_u32 v6, v7, 4, v6
s_lshl_b32 s54, s15, 5
v_add_u32 v6, s54, v6
s_mul_i32 s71, s53, 14336
L_we_254:
s_waitcnt vmcnt(0)
v_lshlrev_b32 v16, 16, v16
s_waitcnt lgkmcnt(0)
s_mov_b64 exec, 1
ds_add_u32 v11, v12 offset:29444
s_mov_b64 exec, -1
s_mov_b32 s58, 2097152
L_lw_256:
ds_read_b32 v13, v11 offset:29444
s_waitcnt lgkmcnt(0)
v_readfirstlane_b32 s54, v13
s_cmp_ge_u32 s54, 4
s_cbranch_scc1 L_ld_257
s_sleep 4
s_sub_u32 s58, s58, 1
s_cmp_lg_u32 s58, 0
s_cbranch_scc1 L_lw_256
L_ld_257:
v_mov_b32 v26, 0
v_mov_b32 v27, 0
v_mov_b32 v28, 0
v_mov_b32 v29, 0
s_cmp_eq_u32 s70, 1
s_cbranch_scc1 L_r1_258
s_cmp_eq_u32 s70, 2
s_cbranch_scc1 L_r2_259
v_lshrrev_b32 v8, 4, v0
v_lshlrev_b32 v8, 11, v8
v_bfe_u32 v7, v0, 2, 2
v_lshl_add_u32 v8, v7, 8, v8
v_and_b32 v7, 3, v0
v_lshl_add_u32 v8, v7, 3, v8
s_lshl_b32 s54, s53, 6
s_add_u32 s54, s54, 30720
v_add_u32 v8, s54, v8
ds_read_b64_tr_b16 v[80:81], v8 offset:0
ds_read_b64_tr_b16 v[82:83], v8 offset:1024
ds_read_b64_tr_b16 v[84:85], v8 offset:8192
ds_read_b64_tr_b16 v[86:87], v8 offset:9216
ds_read_b64_tr_b16 v[88:89], v8 offset:16384
ds_read_b64_tr_b16 v[90:91], v8 offset:17408
ds_read_b64_tr_b16 v[92:93], v8 offset:24576
ds_read_b64_tr_b16 v[94:95], v8 offset:25600
s_waitcnt lgkmcnt(0)
ds_read_b64_tr_b16 v[96:97], v8 offset:32
ds_read_b64_tr_b16 v[98:99], v8 offset:1056
ds_read_b64_tr_b16 v[100:101], v8 offset:8224
ds_read_b64_tr_b16 v[102:103], v8 offset:9248
ds_read_b64_tr_b16 v[104:105], v8 offset:16416
ds_read_b64_tr_b16 v[106:107], v8 offset:17440
ds_read_b64_tr_b16 v[108:109], v8 offset:24608
ds_read_b64_tr_b16 v[110:111], v8 offset:25632
s_waitcnt lgkmcnt(0)
s_branch L_re_260
L_r1_258:
v_lshrrev_b32 v8, 4, v0
v_lshlrev_b32 v8, 9, v8
v_bfe_u32 v7, v0, 2, 2
v_lshl_add_u32 v8, v7, 6, v8
v_and_b32 v7, 1, v0
v_lshl_add_u32 v8, v7, 3, v8
v_bfe_u32 v7, v0, 1, 1
v_lshl_add_u32 v8, v7, 15, v8
s_add_u32 s54, s71, 30720
v_add_u32 v8, s54, v8
s_mul_i32 s55, s14, 147
s_lshr_b32 s55, s55, 11
s_mul_i32 s55, s55, 9216
s_lshl_b32 s54, s14, 2
s_add_u32 s54, s54, s53
s_lshl_b32 s54, s54, 7
s_add_u32 s54, s54, s55
s_add_u32 s54, s54, 3538944
v_and_b32 v27, 0x70, v1
v_lshrrev_b32 v7, 4, v0
v_lshl_add_u32 v27, v7, 16, v27
v_bfe_u32 v7, v0, 3, 1
v_lshlrev_b32 v7, 13, v7
v_add3_u32 v27, v27, v7, s54
s_and_b32 s55, s48, 3
s_lshl_b32 s55, s55, 14
s_lshl_b32 s54, s10, 13
s_add_u32 s54, s54, s55
s_lshl_b32 s55, s53, 11
s_add_u32 s54, s54, s55
s_add_u32 s54, s54, 3407872
v_and_b32 v4, 7, v0
v_lshlrev_b32 v4, 5, v4
v_lshrrev_b32 v7, 5, v0
v_lshl_add_u32 v4, v7, 8, v4
v_and_b32 v7, 16, v0
v_add3_u32 v4, v4, v7, s54
s_mul_i32 s54, s53, 5120
v_add_u32 v10, s54, v1
v_and_b32 v5, 0x17, v0
v_lshlrev_b32 v5, 4, v5
v_bfe_u32 v7, v0, 3, 1
v_lshl_add_u32 v5, v7, 3, v5
v_lshrrev_b32 v7, 5, v0
v_lshl_add_u32 v5, v7, 2, v5
s_lshl_b32 s54, s53, 10
v_add_u32 v5, s54, v5
v_and_b32 v9, 7, v0
v_lshlrev_b32 v9, 4, v9
v_bfe_u32 v7, v0, 2, 1
v_lshl_add_u32 v9, v7, 8, v9
v_and_b32 v7, 3, v0
v_lshl_add_u32 v9, v7, 2, v9
v_add_u32 v160, 1280, v5
v_add_u32 v164, 5376, v9
v_add_u32 v161, 6400, v5
v_add_u32 v165, 10496, v9
v_add_u32 v162, 11520, v5
v_add_u32 v166, 15616, v9
v_add_u32 v163, 16640, v5
v_add_u32 v167, 20736, v9
s_branch L_re_260
L_r2_259:
v_lshrrev_b32 v8, 4, v0
v_lshlrev_b32 v8, 9, v8
v_bfe_u32 v7, v0, 1, 1
v_lshl_add_u32 v8, v7, 8, v8
v_bfe_u32 v7, v0, 2, 2
v_lshl_add_u32 v8, v7, 5, v8
v_and_b32 v7, 1, v0
v_lshl_add_u32 v8, v7, 3, v8
s_add_u32 s55, s71, 30720
v_add_u32 v8, s55, v8
v_bfe_u32 v26, v0, 2, 1
v_lshlrev_b32 v26, 10, v26
v_bfe_u32 v7, v0, 1, 1
v_lshl_add_u32 v26, v7, 8, v26
v_lshrrev_b32 v7, 3, v0
v_lshl_add_u32 v26, v7, 4, v26
v_and_b32 v7, 1, v0
v_lshl_add_u32 v26, v7, 3, v26
s_and_b32 s55, s48, 3
s_lshl_b32 s55, s55, 16
s_lshl_b32 s54, s53, 14
s_add_u32 s54, s54, s55
s_lshl_b32 s55, s10, 13
s_add_u32 s54, s54, s55
s_add_u32 s54, s54, 3542016
v_add_u32 v27, s54, v1
s_mov_b32 s54, s15
s_lshl_b32 s55, s54, 5
v_lshrrev_b32 v28, 3, v0
v_lshlrev_b32 v28, 10, v28
v_and_b32 v7, 7, v0
v_lshl_add_u32 v28, v7, 2, v28
v_add_u32 v28, s55, v28
s_lshl_b32 s54, s54, 8
s_and_b32 s55, s48, 3
s_lshl_b32 s55, s55, 14
s_add_u32 s54, s54, s55
s_lshl_b32 s55, s10, 13
s_add_u32 s54, s54, s55
s_add_u32 s54, s54, 3407872
v_lshl_add_u32 v29, v0, 2, s54
s_lshl_b32 s54, s53, 11
v_add_u32 v10, s54, v1
L_re_260:
s_lshl_b32 s54, s53, 9
v_add_u32 v17, s54, v3
s_and_b32 s54, s50, 3
s_lshl_b32 s54, s54, 2
s_add_u32 s54, s54, s53
s_mul_i32 s54, s54, 49152
s_mov_b32 s55, s63
s_lshl_b32 s55, s55, 13
s_add_u32 s54, s54, s55
s_lshr_b32 s6, s50, 3
s_mul_i32 s7, s6, 11
s_lshr_b32 s7, s7, 5
s_mul_i32 s7, s7, 8704
s_lshl_b32 s6, s6, 2
s_add_u32 s6, s6, s51
s_mul_i32 s6, s6, 640
s_add_u32 s54, s54, s6
s_add_u32 s54, s54, s7
s_add_u32 s54, s54, 2621440
v_add_u32 v18, s54, v1
s_and_b32 s54, s67, 15
s_mul_i32 s54, s54, 49152
s_lshl_b32 s55, s62, 13
s_add_u32 s54, s54, s55
s_add_u32 s54, s54, 2621440
v_mul_u32_u24 v7, 11, v2
v_lshrrev_b32 v7, 5, v7
v_mul_u32_u24 v7, 8704, v7
v_mul_u32_u24 v25, 2560, v2
v_add3_u32 v25, v25, v7, s54
v_add_u32 v19, v25, v3
s_lshl_b32 s54, s53, 5
v_mov_b32 v30, s54
v_mul_u32_u24 v20, 272, v2
v_lshrrev_b32 v7, 1, v3
v_add_u32 v20, v20, v7
v_and_b32 v21, 7, v0
v_mul_u32_u24 v21, 272, v21
v_add_u32 v21, v21, v15
s_lshl_b32 s54, s69, 2
s_add_u32 s54, s54, s53
s_lshl_b32 s54, s54, 13
s_add_u32 s54, s54, 2099200
s_mov_b32 s55, s67
v_bfe_u32 v22, v0, 1, 2
v_mov_b32 v7, s55
v_and_b32 v7, 31, v7
v_lshlrev_b32 v22, 17, v22
v_lshl_add_u32 v22, v7, 7, v22
v_and_b32 v7, 1, v0
v_lshl_add_u32 v22, v7, 6, v22
v_add3_u32 v22, v22, v15, s54
s_lshl_b32 s54, s13, 12
s_add_u32 s54, s54, 2097152
v_add_u32 v23, s54, v1
v_mov_b32 v192, -1
v_mov_b32 v193, -1
v_mov_b32 v194, -1
v_mov_b32 v195, -1
v_mov_b32 v196, -1
v_mov_b32 v197, -1
v_mov_b32 v198, -1
v_mov_b32 v199, -1
v_mov_b32 v200, -1
v_mov_b32 v201, -1
v_mov_b32 v202, -1
v_mov_b32 v203, -1
v_mov_b32 v204, -1
v_mov_b32 v205, -1
v_mov_b32 v206, -1
v_mov_b32 v207, -1
v_mov_b32 v208, -1
v_mov_b32 v209, -1
v_mov_b32 v210, -1
v_mov_b32 v211, -1
v_mov_b32 v212, -1
v_mov_b32 v213, -1
v_mov_b32 v214, -1
v_mov_b32 v215, -1
v_mov_b32 v216, -1
v_mov_b32 v217, -1
v_mov_b32 v218, -1
v_mov_b32 v219, -1
v_mov_b32 v220, -1
v_mov_b32 v221, -1
v_mov_b32 v222, -1
v_mov_b32 v223, -1
v_mov_b32 v224, -1
v_mov_b32 v225, -1
v_mov_b32 v226, -1
v_mov_b32 v227, -1
v_mov_b32 v228, -1
v_mov_b32 v229, -1
v_mov_b32 v230, -1
v_mov_b32 v231, -1
v_mov_b32 v232, -1
v_mov_b32 v233, -1
v_mov_b32 v234, -1
v_mov_b32 v235, -1
v_mov_b32 v236, -1
v_mov_b32 v237, -1
v_mov_b32 v238, -1
v_mov_b32 v239, -1
v_mov_b32 v240, -1
v_mov_b32 v241, -1
v_mov_b32 v242, -1
v_mov_b32 v243, -1
v_mov_b32 v244, -1
v_mov_b32 v245, -1
s_waitcnt lgkmcnt(0)
s_mov_b64 vcc, 0
s_mov_b64 s[4:5], -1
s_mov_b64 exec, s[4:5]
s_and_b32 s54, s49, 7
s_lshl_b32 s54, s54, 9
s_add_u32 s54, s54, 3833856
s_add_u32 s40, s38, s54
s_addc_u32 s41, s39, 0
s_cmp_lg_u32 s53, 1
s_cbranch_scc1 L_nf_261
s_mov_b32 s58, 2097152
L_lw_262:
ds_read_b32 v13, v31 offset:28416
s_waitcnt lgkmcnt(0)
v_readfirstlane_b32 s54, v13
s_cmp_ge_u32 s54, 11
s_cbranch_scc1 L_ld_263
s_sleep 2
s_sub_u32 s58, s58, 1
s_cmp_lg_u32 s58, 0
s_cbranch_scc1 L_lw_262
L_ld_263:
s_mov_b32 s43, 1
s_atomic_add s43, s[40:41], 0x0 glc
s_waitcnt lgkmcnt(0)
s_add_u32 s43, s43, 1
s_cmp_ge_u32 s43, 18
s_cselect_b32 s45, 3, 0
s_cmp_ge_u32 s43, 29
s_cselect_b32 s43, 1, s45
v_mov_b32 v13, s43
ds_write_b32 v11, v13 offset:29468
s_mov_b32 s58, 2097152
L_lw_264:
ds_read_b32 v13, v31 offset:28416
s_waitcnt lgkmcnt(0)
v_readfirstlane_b32 s54, v13
s_cmp_ge_u32 s54, 14
s_cbranch_scc1 L_ld_265
s_sleep 2
s_sub_u32 s58, s58, 1
s_cmp_lg_u32 s58, 0
s_cbranch_scc1 L_lw_264
L_ld_265:
s_mov_b32 s43, 1
s_atomic_add s43, s[40:41], 0x1000 glc
s_waitcnt lgkmcnt(0)
s_add_u32 s43, s43, 1
s_cmp_ge_u32 s43, 18
s_cselect_b32 s45, 3, 0
s_cmp_ge_u32 s43, 29
s_cselect_b32 s43, 1, s45
v_mov_b32 v13, s43
ds_write_b32 v11, v13 offset:29468
s_mov_b32 s58, 2097152
L_lw_266:
ds_read_b32 v13, v31 offset:28416
s_waitcnt lgkmcnt(0)
v_readfirstlane_b32 s54, v13
s_cmp_ge_u32 s54, 17
s_cbranch_scc1 L_ld_267
s_sleep 2
s_sub_u32 s58, s58, 1
s_cmp_lg_u32 s58, 0
s_cbranch_scc1 L_lw_266
L_ld_267:
s_mov_b32 s43, 1
s_atomic_add s43, s[40:41], 0x2000 glc
s_waitcnt lgkmcnt(0)
s_add_u32 s43, s43, 1
s_cmp_ge_u32 s43, 18
s_cselect_b32 s45, 3, 0
s_cmp_ge_u32 s43, 29
s_cselect_b32 s43, 1, s45
v_mov_b32 v13, s43
ds_write_b32 v11, v13 offset:29468
s_mov_b32 s58, 2097152
L_lw_268:
ds_read_b32 v13, v31 offset:28416
s_waitcnt lgkmcnt(0)
v_readfirstlane_b32 s54, v13
s_cmp_ge_u32 s54, 20
s_cbranch_scc1 L_ld_269
s_sleep 2
s_sub_u32 s58, s58, 1
s_cmp_lg_u32 s58, 0
s_cbranch_scc1 L_lw_268
L_ld_269:
s_mov_b32 s43, 1
s_atomic_add s43, s[40:41], 0x3000 glc
s_waitcnt lgkmcnt(0)
s_add_u32 s43, s43, 1
s_cmp_ge_u32 s43, 18
s_cselect_b32 s45, 3, 0
s_cmp_ge_u32 s43, 29
s_cselect_b32 s43, 1, s45
v_mov_b32 v13, s43
ds_write_b32 v11, v13 offset:29468
L_nf_261:
s_mov_b32 s58, 2097152
L_lw_270:
ds_read_b32 v13, v11 offset:29476
s_waitcnt lgkmcnt(0)
v_readfirstlane_b32 s54, v13
s_cmp_ge_u32 s54, 4
s_cbranch_scc1 L_ld_271
s_sleep 6
s_sub_u32 s58, s58, 1
s_cmp_lg_u32 s58, 0
s_cbranch_scc1 L_lw_270
L_ld_271:
ds_read_b128 v[64:67], v30 offset:64
ds_read_b128 v[68:71], v30 offset:80
s_waitcnt lgkmcnt(0)
v_max3_f32 v76, v64, v65, v66
v_max_f32 v76, v76, v67
v_pk_add_f32 v[72:73], v[64:65], v[76:77] op_sel_hi:[1,0] neg_lo:[0,1] neg_hi:[0,1]
v_pk_add_f32 v[74:75], v[66:67], v[76:77] op_sel_hi:[1,0] neg_lo:[0,1] neg_hi:[0,1]
v_exp_f32 v72, v72
v_exp_f32 v73, v73
v_exp_f32 v74, v74
v_exp_f32 v75, v75
v_pk_mul_f32 v[68:69], v[68:69], v[72:73]
v_pk_fma_f32 v[68:69], v[70:71], v[74:75], v[68:69]
v_add_f32 v77, v68, v69
s_mov_b32 exec_lo, 0
s_mov_b32 exec_hi, 1
s_cmp_eq_u32 s12, 0
s_cbranch_scc1 L_mlf
global_store_dwordx2 v18, v[76:77], s[38:39]
s_branch L_mld
L_mlf:
global_store_dwordx2 v18, v[76:77], s[38:39] sc1
L_mld:
s_mov_b64 exec, -1
s_cmp_lg_u32 s53, 1
s_cbranch_scc1 L_nf_272
s_mov_b32 s58, 2097152
L_lw_273:
ds_read_b32 v13, v31 offset:28416
s_waitcnt lgkmcnt(0)
v_readfirstlane_b32 s54, v13
s_cmp_ge_u32 s54, 23
s_cbranch_scc1 L_ld_274
s_sleep 2
s_sub_u32 s58, s58, 1
s_cmp_lg_u32 s58, 0
s_cbranch_scc1 L_lw_273
L_ld_274:
s_mov_b32 s43, 1
s_atomic_add s43, s[40:41], 0x4000 glc
s_waitcnt lgkmcnt(0)
s_add_u32 s43, s43, 1
s_cmp_ge_u32 s43, 18
s_cselect_b32 s45, 3, 0
s_cmp_ge_u32 s43, 29
s_cselect_b32 s43, 1, s45
v_mov_b32 v13, s43
ds_write_b32 v11, v13 offset:29468
s_mov_b32 s58, 2097152
L_lw_275:
ds_read_b32 v13, v31 offset:28416
s_waitcnt lgkmcnt(0)
v_readfirstlane_b32 s54, v13
s_cmp_ge_u32 s54, 26
s_cbranch_scc1 L_ld_276
s_sleep 2
s_sub_u32 s58, s58, 1
s_cmp_lg_u32 s58, 0
s_cbranch_scc1 L_lw_275
L_ld_276:
s_mov_b32 s43, 1
s_atomic_add s43, s[40:41], 0x5000 glc
s_waitcnt lgkmcnt(0)
s_add_u32 s43, s43, 1
s_cmp_ge_u32 s43, 18
s_cselect_b32 s45, 3, 0
s_cmp_ge_u32 s43, 29
s_cselect_b32 s43, 1, s45
v_mov_b32 v13, s43
ds_write_b32 v11, v13 offset:29468
L_nf_272:
s_cmp_lg_u32 s70, 3
s_cbranch_scc1 L_nomg
s_mov_b32 s58, 2097152
L_lw_277:
ds_read_b32 v13, v31 offset:28416
s_waitcnt lgkmcnt(0)
v_readfirstlane_b32 s54, v13
s_cmp_ge_u32 s54, 26
s_cbranch_scc1 L_ld_278
s_sleep 6
s_sub_u32 s58, s58, 1
s_cmp_lg_u32 s58, 0
s_cbranch_scc1 L_lw_277
L_ld_278:
s_mov_b32 s61, 131072
L_pl_279:
global_load_dwordx2 v[208:209], v25, s[38:39] offset:512 sc1
global_load_dwordx2 v[210:211], v25, s[38:39] offset:1152 sc1
global_load_dwordx2 v[212:213], v25, s[38:39] offset:1792 sc1
global_load_dwordx2 v[214:215], v25, s[38:39] offset:2432 sc1
s_waitcnt vmcnt(2)
v_max3_u32 v13, v208, v209, v210
s_waitcnt vmcnt(0)
v_max3_u32 v13, v13, v211, v212
v_max3_u32 v13, v13, v213, v214
v_max_u32 v13, v13, v215
v_cmp_eq_u32 vcc, -1, v13
s_cbranch_vccz L_pd_280
s_sleep 16
s_sub_u32 s61, s61, 1
s_cmp_lg_u32 s61, 0
s_cbranch_scc1 L_pl_279
L_pd_280:
v_max3_f32 v68, v208, v210, v212
v_max_f32 v68, v68, v214
v_sub_f32 v64, v208, v68
v_sub_f32 v65, v210, v68
v_sub_f32 v66, v212, v68
v_sub_f32 v67, v214, v68
v_exp_f32 v64, v64
v_exp_f32 v65, v65
v_exp_f32 v66, v66
v_exp_f32 v67, v67
v_mul_f32 v78, v64, v209
v_fmac_f32 v78, v65, v211
v_fmac_f32 v78, v66, v213
v_fmac_f32 v78, v67, v215
v_rcp_f32 v78, v78
s_nop 0
v_pk_mul_f32 v[64:65], v[64:65], v[78:79] op_sel_hi:[1,0]
v_pk_mul_f32 v[66:67], v[66:67], v[78:79] op_sel_hi:[1,0]
L_nomg:
s_cmp_lg_u32 s53, 1
s_cbranch_scc1 L_nf_281
s_mov_b32 s58, 2097152
L_lw_282:
ds_read_b32 v13, v31 offset:28416
s_waitcnt lgkmcnt(0)
v_readfirstlane_b32 s54, v13
s_cmp_ge_u32 s54, 29
s_cbranch_scc1 L_ld_283
s_sleep 2
s_sub_u32 s58, s58, 1
s_cmp_lg_u32 s58, 0
s_cbranch_scc1 L_lw_282
L_ld_283:
s_mov_b32 s43, 1
s_atomic_add s43, s[40:41], 0x6000 glc
s_waitcnt lgkmcnt(0)
s_add_u32 s43, s43, 1
s_cmp_ge_u32 s43, 18
s_cselect_b32 s45, 3, 0
s_cmp_ge_u32 s43, 29
s_cselect_b32 s43, 1, s45
v_mov_b32 v13, s43
ds_write_b32 v11, v13 offset:29468
L_nf_281:
s_waitcnt lgkmcnt(0)
L_tail:
s_barrier
ds_read_b128 v[32:35], v17 offset:19968
ds_read_b128 v[36:39], v17 offset:22016
ds_read_b128 v[40:43], v17 offset:24064
ds_read_b128 v[44:47], v17 offset:26112
s_mov_b32 exec_hi, 0
s_cmp_eq_u32 s12, 0
s_waitcnt lgkmcnt(3)
v_pk_mul_f32 v[32:33], v[32:33], v[72:73] op_sel_hi:[1,0]
v_pk_mul_f32 v[34:35], v[34:35], v[72:73] op_sel_hi:[1,0]
s_waitcnt lgkmcnt(2)
v_pk_fma_f32 v[32:33], v[36:37], v[72:73], v[32:33] op_sel:[0,1,0] op_sel_hi:[1,1,1]
v_pk_fma_f32 v[34:35], v[38:39], v[72:73], v[34:35] op_sel:[0,1,0] op_sel_hi:[1,1,1]
s_waitcnt lgkmcnt(1)
v_pk_fma_f32 v[32:33], v[40:41], v[74:75], v[32:33] op_sel_hi:[1,0,1]
v_pk_fma_f32 v[34:35], v[42:43], v[74:75], v[34:35] op_sel_hi:[1,0,1]
s_waitcnt lgkmcnt(0)
v_pk_fma_f32 v[32:33], v[44:45], v[74:75], v[32:33] op_sel:[0,1,0] op_sel_hi:[1,1,1]
v_pk_fma_f32 v[34:35], v[46:47], v[74:75], v[34:35] op_sel:[0,1,0] op_sel_hi:[1,1,1]
s_cbranch_scc1 L_opf
global_store_dwordx4 v18, v[32:35], s[38:39]
s_branch L_opd
L_opf:
global_store_dwordx4 v18, v[32:35], s[38:39] sc1
L_opd:
s_mov_b64 exec, s[4:5]
s_cmp_lg_u32 s70, 3
s_cbranch_scc1 L_rdone
s_mov_b32 s61, 131072
L_sl_284:
global_load_dwordx4 v[192:195], v19, s[38:39] offset:0 sc1
global_load_dwordx4 v[196:199], v19, s[38:39] offset:640 sc1
global_load_dwordx4 v[200:203], v19, s[38:39] offset:1280 sc1
global_load_dwordx4 v[204:207], v19, s[38:39] offset:1920 sc1
s_waitcnt vmcnt(3)
v_pk_mul_f32 v[48:49], v[192:193], v[64:65] op_sel_hi:[1,0]
v_max3_u32 v13, v192, v193, v194
v_pk_mul_f32 v[50:51], v[194:195], v[64:65] op_sel_hi:[1,0]
s_waitcnt vmcnt(2)
v_pk_fma_f32 v[48:49], v[196:197], v[64:65], v[48:49] op_sel:[0,1,0] op_sel_hi:[1,1,1]
v_max3_u32 v13, v13, v195, v196
v_pk_fma_f32 v[50:51], v[198:199], v[64:65], v[50:51] op_sel:[0,1,0] op_sel_hi:[1,1,1]
v_max3_u32 v13, v13, v197, v198
s_waitcnt vmcnt(1)
v_pk_fma_f32 v[48:49], v[200:201], v[66:67], v[48:49] op_sel_hi:[1,0,1]
v_max3_u32 v13, v13, v199, v200
v_pk_fma_f32 v[50:51], v[202:203], v[66:67], v[50:51] op_sel_hi:[1,0,1]
v_max3_u32 v13, v13, v201, v202
s_waitcnt vmcnt(0)
v_pk_fma_f32 v[48:49], v[204:205], v[66:67], v[48:49] op_sel:[0,1,0] op_sel_hi:[1,1,1]
v_max3_u32 v13, v13, v203, v204
v_pk_fma_f32 v[50:51], v[206:207], v[66:67], v[50:51] op_sel:[0,1,0] op_sel_hi:[1,1,1]
v_max3_u32 v13, v13, v205, v206
v_max_u32 v13, v13, v207
v_cmp_eq_u32 vcc, -1, v13
s_cbranch_vccz L_sd_285
s_sub_u32 s61, s61, 1
s_cmp_lg_u32 s61, 0
s_cbranch_scc1 L_sl_284
L_sd_285:
v_cvt_pk_bf16_f32 v48, v48, v49
v_cvt_pk_bf16_f32 v49, v50, v51
ds_write_b64 v20, v[48:49] offset:9600
s_waitcnt lgkmcnt(0)
s_barrier
ds_read_b128 v[32:35], v21 offset:9600
ds_read_b128 v[36:39], v21 offset:9664
ds_read_b128 v[40:43], v21 offset:9728
ds_read_b128 v[44:47], v21 offset:9792
s_waitcnt lgkmcnt(3)
v_mfma_f32_16x16x32_bf16 v[48:51], v[80:83], v[32:35], 0
v_mfma_f32_16x16x32_bf16 v[52:55], v[96:99], v[32:35], 0
s_waitcnt lgkmcnt(2)
v_mfma_f32_16x16x32_bf16 v[48:51], v[84:87], v[36:39], v[48:51]
v_mfma_f32_16x16x32_bf16 v[52:55], v[100:103], v[36:39], v[52:55]
s_waitcnt lgkmcnt(1)
v_mfma_f32_16x16x32_bf16 v[48:51], v[88:91], v[40:43], v[48:51]
v_mfma_f32_16x16x32_bf16 v[52:55], v[104:107], v[40:43], v[52:55]
s_waitcnt lgkmcnt(0)
v_mfma_f32_16x16x32_bf16 v[48:51], v[92:95], v[44:47], v[48:51]
v_mfma_f32_16x16x32_bf16 v[52:55], v[108:111], v[44:47], v[52:55]
s_mov_b32 exec_lo, 0x00ff00ff
s_mov_b32 exec_hi, 0x00ff00ff
s_nop 4
global_store_dwordx4 v22, v[48:51], s[38:39] offset:-2048 sc1
global_store_dwordx4 v22, v[52:55], s[38:39] offset:2048 sc1
s_mov_b64 exec, -1
s_cmp_lg_u32 s53, 0
s_cbranch_scc1 L_fin
s_mov_b32 s61, 131072
L_al_286:
global_load_dwordx4 v[216:219], v23, s[38:39] offset:0 sc1
global_load_dwordx4 v[220:223], v23, s[38:39] offset:1024 sc1
global_load_dwordx4 v[224:227], v23, s[38:39] offset:2048 sc1
global_load_dwordx4 v[228:231], v23, s[38:39] offset:3072 sc1
s_sleep 1
s_waitcnt vmcnt(28)
v_max3_u32 v13, v216, v217, v218
v_max3_u32 v13, v13, v219, v220
v_max3_u32 v13, v13, v221, v222
v_max3_u32 v13, v13, v223, v224
v_max3_u32 v13, v13, v225, v226
v_max3_u32 v13, v13, v227, v228
v_max3_u32 v13, v13, v229, v230
v_max_u32 v13, v13, v231
v_cmp_eq_u32 vcc, -1, v13
s_cbranch_vccz L_ad_287
s_mov_b64 exec, vcc
s_sub_u32 s61, s61, 1
s_cmp_lg_u32 s61, 0
s_cbranch_scc1 L_al_286
L_ad_287:
s_mov_b64 exec, s[4:5]
v_pk_add_f32 v[32:33], v[216:217], v[220:221]
v_pk_add_f32 v[34:35], v[218:219], v[222:223]
v_pk_add_f32 v[40:41], v[224:225], v[228:229]
v_pk_add_f32 v[42:43], v[226:227], v[230:231]
v_pk_add_f32 v[32:33], v[32:33], v[40:41]
v_pk_add_f32 v[34:35], v[34:35], v[42:43]
s_nop 1
v_permlane32_swap_b32 v32, v34
v_permlane32_swap_b32 v33, v35
v_add_f32 v32, v32, v34
v_add_f32 v33, v33, v35
s_nop 1
v_permlane16_swap_b32 v32, v33
v_add_f32 v32, v32, v33
s_nop 1
v_add_f32_dpp v32, v32, v32 row_ror:8 row_mask:0xf bank_mask:0xf
v_cvt_pk_bf16_f32 v32, 0, v32
v_add_f32 v32, v32, v16
v_mov_b32 v33, v32
s_nop 1
v_permlane16_swap_b32 v32, v33
v_cvt_pk_bf16_f32 v32, v32, v33
v_min_u32 v32, -2, v32
v_mov_b32 v33, v32
s_nop 1
v_permlane32_swap_b32 v32, v33
global_store_dwordx2 v24, v[32:33], s[38:39] sc1
s_branch L_fin
L_rdone:
s_cmp_eq_u32 s70, 2
s_cbranch_scc1 L_ffn2
s_cmp_eq_u32 s70, 0
s_cbranch_scc1 L_fin
s_and_b32 s6, s14, 1
s_cmp_eq_u32 s70, 4
s_cselect_b32 s6, 2, s6
s_mul_i32 s6, s6, 2
s_add_u32 s6, s6, 1
s_mul_i32 s7, s6, 57344
v_add_u32 v7, s7, v6
s_lshl_b32 s7, s6, 10
s_add_u32 s7, s7, s71
s_add_u32 m0, s7, 30720
s_add_u32 s6, s6, 1
global_load_lds_dwordx4 v7, s[28:29]
s_add_u32 m0, s7, 63488
s_cmp_eq_u32 s6, 8
s_cselect_b32 s6, 1, s6
global_load_lds_dwordx4 v7, s[30:31]
s_mul_i32 s7, s6, 57344
v_add_u32 v7, s7, v6
s_lshl_b32 s7, s6, 10
s_add_u32 s7, s7, s71
s_add_u32 m0, s7, 30720
s_add_u32 s6, s6, 1
global_load_lds_dwordx4 v7, s[28:29]
s_add_u32 m0, s7, 63488
s_cmp_eq_u32 s6, 8
s_cselect_b32 s6, 1, s6
global_load_lds_dwordx4 v7, s[30:31]
s_mul_i32 s7, s6, 57344
v_add_u32 v7, s7, v6
s_lshl_b32 s7, s6, 10
s_add_u32 s7, s7, s71
s_add_u32 m0, s7, 30720
s_add_u32 s6, s6, 1
global_load_lds_dwordx4 v7, s[28:29]
s_add_u32 m0, s7, 63488
s_cmp_eq_u32 s6, 8
s_cselect_b32 s6, 1, s6
global_load_lds_dwordx4 v7, s[30:31]
s_cmp_eq_u32 s70, 4
s_cbranch_scc1 L_fin
s_mul_i32 s7, s6, 57344
v_add_u32 v7, s7, v6
s_lshl_b32 s7, s6, 10
s_add_u32 s7, s7, s71
s_add_u32 m0, s7, 30720
s_add_u32 s6, s6, 1
global_load_lds_dwordx4 v7, s[28:29]
s_add_u32 m0, s7, 63488
s_cmp_eq_u32 s6, 8
s_cselect_b32 s6, 1, s6
global_load_lds_dwordx4 v7, s[30:31]
s_mul_i32 s7, s6, 57344
v_add_u32 v7, s7, v6
s_lshl_b32 s7, s6, 10
s_add_u32 s7, s7, s71
s_add_u32 m0, s7, 30720
s_add_u32 s6, s6, 1
global_load_lds_dwordx4 v7, s[28:29]
s_add_u32 m0, s7, 63488
s_cmp_eq_u32 s6, 8
s_cselect_b32 s6, 1, s6
global_load_lds_dwordx4 v7, s[30:31]
s_mul_i32 s7, s6, 57344
v_add_u32 v7, s7, v6
s_lshl_b32 s7, s6, 10
s_add_u32 s7, s7, s71
s_add_u32 m0, s7, 30720
s_add_u32 s6, s6, 1
global_load_lds_dwordx4 v7, s[28:29]
s_add_u32 m0, s7, 63488
s_cmp_eq_u32 s6, 8
s_cselect_b32 s6, 1, s6
global_load_lds_dwordx4 v7, s[30:31]
s_mul_i32 s7, s6, 57344
v_add_u32 v7, s7, v6
s_lshl_b32 s7, s6, 10
s_add_u32 s7, s7, s71
s_add_u32 m0, s7, 30720
s_add_u32 s6, s6, 1
global_load_lds_dwordx4 v7, s[28:29]
s_add_u32 m0, s7, 63488
s_cmp_eq_u32 s6, 8
s_cselect_b32 s6, 1, s6
global_load_lds_dwordx4 v7, s[30:31]
s_mov_b32 exec_lo, 0xff00ff00
s_mov_b32 exec_hi, 0xff00ff00
v_mov_b32 v216, 0x3f803f80
v_mov_b32 v217, 0x3f803f80
v_mov_b32 v218, 0x3f803f80
v_mov_b32 v219, 0x3f803f80
v_mov_b32 v220, 0x3f803f80
v_mov_b32 v221, 0x3f803f80
v_mov_b32 v222, 0x3f803f80
v_mov_b32 v223, 0x3f803f80
v_mov_b32 v224, 0x3f803f80
v_mov_b32 v225, 0x3f803f80
v_mov_b32 v226, 0x3f803f80
v_mov_b32 v227, 0x3f803f80
v_mov_b32 v228, 0x3f803f80
v_mov_b32 v229, 0x3f803f80
v_mov_b32 v230, 0x3f803f80
v_mov_b32 v231, 0x3f803f80
s_mov_b64 exec, -1
s_waitcnt vmcnt(0)
s_mov_b32 s61, 131072
s_mov_b32 exec_lo, 0x00ff00ff
s_mov_b32 exec_hi, 0x00ff00ff
global_load_dwordx4 v[216:219], v4, s[38:39] offset:0 sc1
global_load_dwordx4 v[220:223], v4, s[38:39] offset:512 sc1
global_load_dwordx4 v[224:227], v4, s[38:39] offset:1024 sc1
global_load_dwordx4 v[228:231], v4, s[38:39] offset:1536 sc1
s_mov_b64 exec, -1
s_waitcnt vmcnt(4)
ds_read_b64_tr_b16 v[96:97], v8 offset:0
ds_read_b64_tr_b16 v[98:99], v8 offset:256
ds_read_b64_tr_b16 v[100:101], v8 offset:2048
ds_read_b64_tr_b16 v[102:103], v8 offset:2304
ds_read_b64_tr_b16 v[104:105], v8 offset:4096
ds_read_b64_tr_b16 v[106:107], v8 offset:4352
ds_read_b64_tr_b16 v[108:109], v8 offset:6144
ds_read_b64_tr_b16 v[110:111], v8 offset:6400
s_waitcnt lgkmcnt(4)
ds_read_b64_tr_b16 v[112:113], v8 offset:16
ds_read_b64_tr_b16 v[114:115], v8 offset:272
ds_read_b64_tr_b16 v[116:117], v8 offset:2064
ds_read_b64_tr_b16 v[118:119], v8 offset:2320
ds_read_b64_tr_b16 v[120:121], v8 offset:4112
ds_read_b64_tr_b16 v[122:123], v8 offset:4368
ds_read_b64_tr_b16 v[124:125], v8 offset:6160
ds_read_b64_tr_b16 v[126:127], v8 offset:6416
s_waitcnt lgkmcnt(4)
ds_read_b64_tr_b16 v[128:129], v8 offset:32
ds_read_b64_tr_b16 v[130:131], v8 offset:288
ds_read_b64_tr_b16 v[132:133], v8 offset:2080
ds_read_b64_tr_b16 v[134:135], v8 offset:2336
ds_read_b64_tr_b16 v[136:137], v8 offset:4128
ds_read_b64_tr_b16 v[138:139], v8 offset:4384
ds_read_b64_tr_b16 v[140:141], v8 offset:6176
ds_read_b64_tr_b16 v[142:143], v8 offset:6432
s_waitcnt lgkmcnt(4)
ds_read_b64_tr_b16 v[144:145], v8 offset:48
ds_read_b64_tr_b16 v[146:147], v8 offset:304
ds_read_b64_tr_b16 v[148:149], v8 offset:2096
ds_read_b64_tr_b16 v[150:151], v8 offset:2352
ds_read_b64_tr_b16 v[152:153], v8 offset:4144
ds_read_b64_tr_b16 v[154:155], v8 offset:4400
ds_read_b64_tr_b16 v[156:157], v8 offset:6192
ds_read_b64_tr_b16 v[158:159], v8 offset:6448
s_waitcnt lgkmcnt(0)
s_branch L_sm_291
L_sl_289:
s_mov_b32 exec_lo, 0x00ff00ff
s_mov_b32 exec_hi, 0x00ff00ff
global_load_dwordx4 v[216:219], v4, s[38:39] offset:0 sc1
global_load_dwordx4 v[220:223], v4, s[38:39] offset:512 sc1
global_load_dwordx4 v[224:227], v4, s[38:39] offset:1024 sc1
global_load_dwordx4 v[228:231], v4, s[38:39] offset:1536 sc1
s_mov_b64 exec, -1
L_sm_291:
s_waitcnt vmcnt(3)
v_mfma_f32_16x16x32_bf16 v[48:51], v[216:219], v[216:219], 0
v_max3_u32 v13, v216, v217, v218
v_mfma_f32_16x16x32_bf16 v[32:35], v[96:99], v[216:219], 0
v_mfma_f32_16x16x32_bf16 v[36:39], v[112:115], v[216:219], 0
v_mfma_f32_16x16x32_bf16 v[40:43], v[128:131], v[216:219], 0
v_mfma_f32_16x16x32_bf16 v[44:47], v[144:147], v[216:219], 0
s_waitcnt vmcnt(2)
v_max3_u32 v13, v13, v219, v220
v_max3_u32 v13, v13, v221, v222
s_waitcnt vmcnt(1)
v_max3_u32 v13, v13, v223, v224
v_max3_u32 v13, v13, v225, v226
s_waitcnt vmcnt(0)
v_max3_u32 v13, v13, v227, v228
v_max3_u32 v13, v13, v229, v230
v_max_u32 v13, v13, v231
v_cmp_eq_u32 vcc, -1, v13
s_cbranch_vccz L_sd_290
s_sub_u32 s61, s61, 1
s_cmp_lg_u32 s61, 0
s_cbranch_scc1 L_sl_289
L_sd_290:
v_mfma_f32_16x16x32_bf16 v[48:51], v[220:223], v[220:223], v[48:51]
v_mfma_f32_16x16x32_bf16 v[32:35], v[100:103], v[220:223], v[32:35]
v_mfma_f32_16x16x32_bf16 v[36:39], v[116:119], v[220:223], v[36:39]
v_mfma_f32_16x16x32_bf16 v[40:43], v[132:135], v[220:223], v[40:43]
v_mfma_f32_16x16x32_bf16 v[44:47], v[148:151], v[220:223], v[44:47]
v_mfma_f32_16x16x32_bf16 v[48:51], v[224:227], v[224:227], v[48:51]
v_mfma_f32_16x16x32_bf16 v[32:35], v[104:107], v[224:227], v[32:35]
v_mfma_f32_16x16x32_bf16 v[36:39], v[120:123], v[224:227], v[36:39]
v_mfma_f32_16x16x32_bf16 v[40:43], v[136:139], v[224:227], v[40:43]
v_mfma_f32_16x16x32_bf16 v[44:47], v[152:155], v[224:227], v[44:47]
v_mfma_f32_16x16x32_bf16 v[48:51], v[228:231], v[228:231], v[48:51]
v_mfma_f32_16x16x32_bf16 v[32:35], v[108:111], v[228:231], v[32:35]
v_mfma_f32_16x16x32_bf16 v[36:39], v[124:127], v[228:231], v[36:39]
v_mfma_f32_16x16x32_bf16 v[40:43], v[140:143], v[228:231], v[40:43]
v_mfma_f32_16x16x32_bf16 v[44:47], v[156:159], v[228:231], v[44:47]
s_nop 3
ds_write_b128 v10, v[48:51] offset:5376
ds_write_b128 v10, v[32:35] offset:1280
ds_write_b128 v10, v[36:39] offset:2304
ds_write_b128 v10, v[40:43] offset:3328
ds_write_b128 v10, v[44:47] offset:4352
s_waitcnt lgkmcnt(0)
s_barrier
ds_read2_b32 v[52:53], v164 offset0:0 offset1:32
ds_read2_b32 v[54:55], v165 offset0:0 offset1:32
ds_read2_b32 v[56:57], v166 offset0:0 offset1:32
ds_read2_b32 v[58:59], v167 offset0:0 offset1:32
ds_read2_b32 v[60:61], v160 offset0:0 offset1:32
ds_read2_b32 v[68:69], v160 offset0:128 offset1:160
ds_read2_b32 v[62:63], v161 offset0:0 offset1:32
ds_read2_b32 v[70:71], v161 offset0:128 offset1:160
ds_read2_b32 v[64:65], v162 offset0:0 offset1:32
ds_read2_b32 v[72:73], v162 offset0:128 offset1:160
ds_read2_b32 v[66:67], v163 offset0:0 offset1:32
ds_read2_b32 v[74:75], v163 offset0:128 offset1:160
s_waitcnt lgkmcnt(8)
v_pk_add_f32 v[52:53], v[52:53], v[54:55]
v_pk_add_f32 v[56:57], v[56:57], v[58:59]
v_pk_add_f32 v[52:53], v[52:53], v[56:57]
v_mul_f32 v53, 0xbb000000, v53
v_mul_f32 v52, 0x3b000000, v52
v_fma_f32 v52, -v53, v53, v52
v_cvt_pk_bf16_f32 v53, 0, v53
v_max_f32 v52, 0, v52
v_cvt_pk_bf16_f32 v52, 0, v52
v_add_f32 v52, 0x3727c5ac, v52
v_cvt_pk_bf16_f32 v52, 0, v52
v_sqrt_f32 v52, v52
s_waitcnt lgkmcnt(0)
v_pk_add_f32 v[60:61], v[60:61], v[62:63]
v_cvt_pk_bf16_f32 v52, 0, v52
v_pk_add_f32 v[64:65], v[64:65], v[66:67]
v_rcp_f32 v52, v52
v_pk_add_f32 v[68:69], v[68:69], v[70:71]
v_pk_add_f32 v[72:73], v[72:73], v[74:75]
v_pk_add_f32 v[60:61], v[60:61], v[64:65]
v_pk_add_f32 v[68:69], v[68:69], v[72:73]
v_fmac_f32 v60, v53, v61
v_fmac_f32 v68, v53, v69
v_mul_f32 v60, v60, v52
v_mul_f32 v68, v68, v52
v_cvt_pk_bf16_f32 v32, 0, v60
v_cvt_pk_bf16_f32 v36, 0, v68
v_mul_f32 v33, v32, v32
v_mul_f32 v33, 0x3d372713, v33
v_fma_f32 v33, v33, v32, v32
v_mul_f32 v33, 0xc0135761, v33
v_exp_f32 v33, v33
s_nop 0
v_add_f32 v33, 1.0, v33
v_rcp_f32 v33, v33
s_nop 0
v_mul_f32 v33, v33, v32
v_cvt_pk_bf16_f32 v33, 0, v33
v_mul_f32 v33, v33, v36
v_mov_b32 v34, v33
s_nop 1
v_permlane32_swap_b32 v33, v34
v_cvt_pk_bf16_f32 v33, v33, v34
v_min_u32 v36, -2, v33
v_mov_b32 v32, v36
v_mov_b32 v33, v36
s_nop 0
v_mov_b32_dpp v32, v36 row_ror:8 row_mask:0xf bank_mask:0xc
v_mov_b32_dpp v33, v36 row_ror:8 row_mask:0xf bank_mask:0x3
v_mov_b32 v34, v32
v_mov_b32 v35, v33
s_nop 0
v_permlane16_swap_b32 v32, v34
v_permlane16_swap_b32 v33, v35
global_store_dwordx4 v27, v[32:35], s[38:39] sc1
L_fin:
s_waitcnt vmcnt(0)
s_endpgm
L_ffn2:
s_lshr_b32 s8, s15, 2
s_cmp_eq_u32 s8, 3
s_cselect_b32 s8, 0, 0
s_sub_u32 s9, 14, s8
s_and_b32 s6, s15, 3
s_mul_i32 s6, s6, s9
s_lshr_b32 s6, s6, 2
s_add_u32 s6, s6, s8
s_lshl_b32 s7, s6, 15
v_add_u32 v7, s7, v6
s_lshl_b32 s7, s6, 10
s_add_u32 s7, s7, s71
s_add_u32 m0, s7, 30720
s_add_u32 s6, s6, 1
global_load_lds_dwordx4 v7, s[32:33]
s_cmp_eq_u32 s6, 14
s_cselect_b32 s6, s8, s6
s_lshl_b32 s7, s6, 15
v_add_u32 v7, s7, v6
s_lshl_b32 s7, s6, 10
s_add_u32 s7, s7, s71
s_add_u32 m0, s7, 30720
s_add_u32 s6, s6, 1
global_load_lds_dwordx4 v7, s[32:33]
s_cmp_eq_u32 s6, 14
s_cselect_b32 s6, s8, s6
s_lshl_b32 s7, s6, 15
v_add_u32 v7, s7, v6
s_lshl_b32 s7, s6, 10
s_add_u32 s7, s7, s71
s_add_u32 m0, s7, 30720
s_add_u32 s6, s6, 1
global_load_lds_dwordx4 v7, s[32:33]
s_cmp_eq_u32 s6, 14
s_cselect_b32 s6, s8, s6
s_lshl_b32 s7, s6, 15
v_add_u32 v7, s7, v6
s_lshl_b32 s7, s6, 10
s_add_u32 s7, s7, s71
s_add_u32 m0, s7, 30720
s_add_u32 s6, s6, 1
global_load_lds_dwordx4 v7, s[32:33]
s_cmp_eq_u32 s6, 14
s_cselect_b32 s6, s8, s6
s_lshl_b32 s7, s6, 15
v_add_u32 v7, s7, v6
s_lshl_b32 s7, s6, 10
s_add_u32 s7, s7, s71
s_add_u32 m0, s7, 30720
s_add_u32 s6, s6, 1
global_load_lds_dwordx4 v7, s[32:33]
s_cmp_eq_u32 s6, 14
s_cselect_b32 s6, s8, s6
s_lshl_b32 s7, s6, 15
v_add_u32 v7, s7, v6
s_lshl_b32 s7, s6, 10
s_add_u32 s7, s7, s71
s_add_u32 m0, s7, 30720
s_add_u32 s6, s6, 1
global_load_lds_dwordx4 v7, s[32:33]
s_cmp_eq_u32 s6, 14
s_cselect_b32 s6, s8, s6
s_lshl_b32 s7, s6, 15
v_add_u32 v7, s7, v6
s_lshl_b32 s7, s6, 10
s_add_u32 s7, s7, s71
s_add_u32 m0, s7, 30720
s_add_u32 s6, s6, 1
global_load_lds_dwordx4 v7, s[32:33]
s_cmp_eq_u32 s6, 14
s_cselect_b32 s6, s8, s6
s_lshl_b32 s7, s6, 15
v_add_u32 v7, s7, v6
s_lshl_b32 s7, s6, 10
s_add_u32 s7, s7, s71
s_add_u32 m0, s7, 30720
s_add_u32 s6, s6, 1
global_load_lds_dwordx4 v7, s[32:33]
s_cmp_eq_u32 s6, 14
s_cselect_b32 s6, s8, s6
s_lshl_b32 s7, s6, 15
v_add_u32 v7, s7, v6
s_lshl_b32 s7, s6, 10
s_add_u32 s7, s7, s71
s_add_u32 m0, s7, 30720
s_add_u32 s6, s6, 1
global_load_lds_dwordx4 v7, s[32:33]
s_cmp_eq_u32 s6, 14
s_cselect_b32 s6, s8, s6
s_lshl_b32 s7, s6, 15
v_add_u32 v7, s7, v6
s_lshl_b32 s7, s6, 10
s_add_u32 s7, s7, s71
s_add_u32 m0, s7, 30720
s_add_u32 s6, s6, 1
global_load_lds_dwordx4 v7, s[32:33]
s_cmp_eq_u32 s6, 14
s_cselect_b32 s6, s8, s6
s_lshl_b32 s7, s6, 15
v_add_u32 v7, s7, v6
s_lshl_b32 s7, s6, 10
s_add_u32 s7, s7, s71
s_add_u32 m0, s7, 30720
s_add_u32 s6, s6, 1
global_load_lds_dwordx4 v7, s[32:33]
s_cmp_eq_u32 s6, 14
s_cselect_b32 s6, s8, s6
s_lshl_b32 s7, s6, 15
v_add_u32 v7, s7, v6
s_lshl_b32 s7, s6, 10
s_add_u32 s7, s7, s71
s_add_u32 m0, s7, 30720
s_add_u32 s6, s6, 1
global_load_lds_dwordx4 v7, s[32:33]
s_cmp_eq_u32 s6, 14
s_cselect_b32 s6, s8, s6
s_lshl_b32 s7, s6, 15
v_add_u32 v7, s7, v6
s_lshl_b32 s7, s6, 10
s_add_u32 s7, s7, s71
s_add_u32 m0, s7, 30720
s_add_u32 s6, s6, 1
global_load_lds_dwordx4 v7, s[32:33]
s_cmp_eq_u32 s6, 14
s_cselect_b32 s6, s8, s6
s_lshl_b32 s7, s6, 15
v_add_u32 v7, s7, v6
s_lshl_b32 s7, s6, 10
s_add_u32 s7, s7, s71
s_add_u32 m0, s7, 30720
s_add_u32 s6, s6, 1
global_load_lds_dwordx4 v7, s[32:33]
s_cmp_eq_u32 s6, 14
s_cselect_b32 s6, s8, s6
L_d2d:
s_waitcnt vmcnt(0)
global_load_dword v60, v29, s[38:39] sc1
s_waitcnt vmcnt(1)
ds_read_b64_tr_b16 v[96:97], v8 offset:0
ds_read_b64_tr_b16 v[98:99], v8 offset:128
ds_read_b64_tr_b16 v[100:101], v8 offset:16
ds_read_b64_tr_b16 v[102:103], v8 offset:144
s_waitcnt lgkmcnt(4)
ds_read_b64_tr_b16 v[104:105], v8 offset:2048
ds_read_b64_tr_b16 v[106:107], v8 offset:2176
ds_read_b64_tr_b16 v[108:109], v8 offset:2064
ds_read_b64_tr_b16 v[110:111], v8 offset:2192
ds_read_b64_tr_b16 v[112:113], v8 offset:4096
ds_read_b64_tr_b16 v[114:115], v8 offset:4224
ds_read_b64_tr_b16 v[116:117], v8 offset:4112
ds_read_b64_tr_b16 v[118:119], v8 offset:4240
s_waitcnt lgkmcnt(4)
ds_read_b64_tr_b16 v[120:121], v8 offset:6144
ds_read_b64_tr_b16 v[122:123], v8 offset:6272
ds_read_b64_tr_b16 v[124:125], v8 offset:6160
ds_read_b64_tr_b16 v[126:127], v8 offset:6288
ds_read_b64_tr_b16 v[128:129], v8 offset:8192
ds_read_b64_tr_b16 v[130:131], v8 offset:8320
ds_read_b64_tr_b16 v[132:133], v8 offset:8208
ds_read_b64_tr_b16 v[134:135], v8 offset:8336
s_waitcnt lgkmcnt(4)
ds_read_b64_tr_b16 v[136:137], v8 offset:10240
ds_read_b64_tr_b16 v[138:139], v8 offset:10368
ds_read_b64_tr_b16 v[140:141], v8 offset:10256
ds_read_b64_tr_b16 v[142:143], v8 offset:10384
ds_read_b64_tr_b16 v[144:145], v8 offset:12288
ds_read_b64_tr_b16 v[146:147], v8 offset:12416
ds_read_b64_tr_b16 v[148:149], v8 offset:12304
ds_read_b64_tr_b16 v[150:151], v8 offset:12432
s_waitcnt lgkmcnt(0)
s_waitcnt vmcnt(0)
v_cmp_eq_u32 vcc, -1, v60
s_cbranch_vccz L_hok
s_mov_b32 s61, 131072
L_hp_292:
global_load_dword v60, v29, s[38:39] sc1
s_waitcnt vmcnt(0)
v_cmp_eq_u32 vcc, -1, v60
s_cbranch_vccz L_hd_293
s_sub_u32 s61, s61, 1
s_cmp_lg_u32 s61, 0
s_cbranch_scc1 L_hp_292
L_hd_293:
L_hok:
v_and_b32 v61, s60, v60
v_lshlrev_b32 v60, 16, v60
s_mov_b32 s61, 131072
L_sl_294:
global_load_dwordx4 v[216:219], v27, s[38:39] offset:-3072 sc1
global_load_dwordx4 v[220:223], v27, s[38:39] offset:-2048 sc1
global_load_dwordx4 v[224:227], v27, s[38:39] offset:-1024 sc1
global_load_dwordx4 v[228:231], v27, s[38:39] offset:0 sc1
global_load_dwordx4 v[232:235], v27, s[38:39] offset:1024 sc1
global_load_dwordx4 v[236:239], v27, s[38:39] offset:2048 sc1
global_load_dwordx4 v[240:243], v27, s[38:39] offset:3072 sc1
s_waitcnt vmcnt(6)
v_mfma_f32_16x16x32_bf16 v[64:67], v[96:99], v[216:219], 0
v_max3_u32 v13, v216, v217, v218
v_mfma_f32_16x16x32_bf16 v[68:71], v[100:103], v[216:219], 0
s_waitcnt vmcnt(5)
v_mfma_f32_16x16x32_bf16 v[64:67], v[104:107], v[220:223], v[64:67]
v_max3_u32 v13, v13, v219, v220
v_mfma_f32_16x16x32_bf16 v[68:71], v[108:111], v[220:223], v[68:71]
v_max3_u32 v13, v13, v221, v222
s_waitcnt vmcnt(4)
v_mfma_f32_16x16x32_bf16 v[64:67], v[112:115], v[224:227], v[64:67]
v_max3_u32 v13, v13, v223, v224
v_mfma_f32_16x16x32_bf16 v[68:71], v[116:119], v[224:227], v[68:71]
v_max3_u32 v13, v13, v225, v226
s_waitcnt vmcnt(3)
v_mfma_f32_16x16x32_bf16 v[64:67], v[120:123], v[228:231], v[64:67]
v_max3_u32 v13, v13, v227, v228
v_mfma_f32_16x16x32_bf16 v[68:71], v[124:127], v[228:231], v[68:71]
v_max3_u32 v13, v13, v229, v230
s_waitcnt vmcnt(2)
v_mfma_f32_16x16x32_bf16 v[64:67], v[128:131], v[232:235], v[64:67]
v_max3_u32 v13, v13, v231, v232
v_mfma_f32_16x16x32_bf16 v[68:71], v[132:135], v[232:235], v[68:71]
v_max3_u32 v13, v13, v233, v234
s_waitcnt vmcnt(1)
v_mfma_f32_16x16x32_bf16 v[64:67], v[136:139], v[236:239], v[64:67]
v_max3_u32 v13, v13, v235, v236
v_mfma_f32_16x16x32_bf16 v[68:71], v[140:143], v[236:239], v[68:71]
v_max3_u32 v13, v13, v237, v238
s_waitcnt vmcnt(0)
v_mfma_f32_16x16x32_bf16 v[64:67], v[144:147], v[240:243], v[64:67]
v_max3_u32 v13, v13, v239, v240
v_mfma_f32_16x16x32_bf16 v[68:71], v[148:151], v[240:243], v[68:71]
v_max3_u32 v13, v13, v241, v242
v_max_u32 v13, v13, v243
v_cmp_eq_u32 vcc, -1, v13
s_cbranch_vccz L_sd_295
s_sub_u32 s61, s61, 1
s_cmp_lg_u32 s61, 0
s_cbranch_scc1 L_sl_294
L_sd_295:
s_nop 3
ds_write_b128 v10, v[64:67] offset:11776
ds_write_b128 v10, v[68:71] offset:12800
s_waitcnt lgkmcnt(0)
s_barrier
s_cmp_lg_u32 s53, 0
s_cbranch_scc1 L_fin
ds_read_b64 v[32:33], v26 offset:11776
ds_read_b64 v[34:35], v26 offset:12416
ds_read_b64 v[36:37], v26 offset:13824
ds_read_b64 v[38:39], v26 offset:14464
ds_read_b64 v[40:41], v26 offset:15872
ds_read_b64 v[42:43], v26 offset:16512
ds_read_b64 v[44:45], v26 offset:17920
ds_read_b64 v[46:47], v26 offset:18560
s_waitcnt lgkmcnt(0)
v_pk_add_f32 v[32:33], v[32:33], v[34:35]
v_pk_add_f32 v[36:37], v[36:37], v[38:39]
v_pk_add_f32 v[40:41], v[40:41], v[42:43]
v_pk_add_f32 v[44:45], v[44:45], v[46:47]
v_pk_add_f32 v[32:33], v[32:33], v[36:37]
v_pk_add_f32 v[40:41], v[40:41], v[44:45]
v_pk_add_f32 v[32:33], v[32:33], v[40:41]
v_cvt_pk_bf16_f32 v32, 0, v32
v_cvt_pk_bf16_f32 v33, 0, v33
v_pk_add_f32 v[32:33], v[32:33], v[60:61]
v_cvt_pk_bf16_f32 v32, v32, v33
global_store_dword v28, v32, s[34:35]
L_end:
s_endpgm
L_last:
.section .rodata,"a"
.p2align 6
.amdhsa_kernel sequential_preLN__gqa_block_cached__geglu_ffn__decode_kernel
  .amdhsa_next_free_vgpr 256
  .amdhsa_next_free_sgpr 102
  .amdhsa_accum_offset 256
  .amdhsa_group_segment_fixed_size 0
  .amdhsa_kernarg_size 96
  .amdhsa_user_sgpr_count 2
  .amdhsa_user_sgpr_kernarg_segment_ptr 1
  .amdhsa_system_sgpr_workgroup_id_x 1
  .amdhsa_float_denorm_mode_32 3
  .amdhsa_float_denorm_mode_16_64 3
.end_amdhsa_kernel
```
